```python
import torch

def _softmax(x, axis=-1):
    return torch.softmax(x, dim=axis)
def _gelu(x):
    return torch.nn.functional.gelu(x, approximate="tanh")
def _silu(x):
    return torch.nn.functional.silu(x)
def _sigmoid(x):
    return torch.sigmoid(x)
def _layernorm(x, axis=-1, eps=1e-5):
    m = x.mean(dim=axis, keepdim=True)
    v = x.var(dim=axis, keepdim=True, unbiased=False)
    return (x - m) / torch.sqrt(v + eps)
def _scatter_add(tgt, idx, src, axis=0):
    return tgt.clone().index_add_(axis, idx, src)
def _segment_sum(src, seg, n):
    out = torch.zeros((n,) + src.shape[1:], dtype=src.dtype)
    return out.index_add_(0, seg, src)
def _pad(x, pw):
    flat = tuple(v for pair in reversed(pw) for v in pair)
    return torch.nn.functional.pad(x, flat)

kernel_name = 'gated_mix__sliding_local_dilated__spectral_fnet__prompt'

def setup_inputs():

    _w = (lambda a: (lambda t: t.to(torch.bfloat16) if t.is_floating_point() else t)(torch.as_tensor(a)))
    def _A_setup():
        B, S, D = 1, 2048, 1024
        return {
            "x": _w((lambda *s: torch.randn(*s, dtype=torch.bfloat16) * 0.05)(B, S, D)),
            "wqkv": _w((lambda *s: torch.randn(*s, dtype=torch.bfloat16) * 1.6)(D, 3 * D)),
            "wo": _w((lambda *s: torch.randn(*s, dtype=torch.bfloat16) * 0.2)(D, D)),
        }
    _A_in = _A_setup()

    def _B_setup():
        B, S, D = 1, 2048, 1024
        ns = torch.arange(S)[:, None] * torch.arange(S)[None, :]
        nd = torch.arange(D)[:, None] * torch.arange(D)[None, :]
        Ws_re = torch.cos(-2.0 * torch.pi * ns / S).to(float)
        Ws_im = torch.sin(-2.0 * torch.pi * ns / S).to(float)
        Wd_re = torch.cos(-2.0 * torch.pi * nd / D).to(float)
        Wd_im = torch.sin(-2.0 * torch.pi * nd / D).to(float)
        return {
            "x": _w((lambda *s: torch.randn(*s, dtype=torch.bfloat16) * 0.05)(B, S, D)),
            "dft_seq_re": _w(Ws_re),
            "dft_seq_im": _w(Ws_im),
            "dft_hid_re": _w(Wd_re),
            "dft_hid_im": _w(Wd_im),
        }
    _B_in = _B_setup()

    return {
        "A_x": _A_in["x"],
        "A_wqkv": _A_in["wqkv"],
        "A_wo": _A_in["wo"],
        "B_x": _B_in["x"],
        "B_dft_seq_re": _B_in["dft_seq_re"],
        "B_dft_seq_im": _B_in["dft_seq_im"],
        "B_dft_hid_re": _B_in["dft_hid_re"],
        "B_dft_hid_im": _B_in["dft_hid_im"],
        "gate_w": _w((lambda *s: torch.randn(*s, dtype=torch.bfloat16) * 0.05)(1024) * 16.0),
    }

def reference(A_x, A_wqkv, A_wo, B_x, B_dft_seq_re, B_dft_seq_im, B_dft_hid_re, B_dft_hid_im, gate_w):
    def _A_ref(x, wqkv, wo):
        B, S, D = x.shape
        H = 32; Dh = D // H
        W, dil = 8, 2
        qkv = (lambda x, *d: x.permute(*d))((x @ wqkv).reshape(B, S, 3, H, Dh), 2, 0, 3, 1, 4)
        q, k, v = qkv[0], qkv[1], qkv[2]
        scale = Dh ** -0.5
        pos = torch.arange(S)
        off = torch.arange(W) * dil
        idx = pos[:, None] - off[None, :]
        mask = idx >= 0
        idx_c = torch.where(mask, idx, 0).reshape(-1)
        kg = k[:, :, idx_c, :].reshape(B, H, S, W, Dh)
        vg = v[:, :, idx_c, :].reshape(B, H, S, W, Dh)
        logits = torch.einsum("bhsd,bhswd->bhsw", q, kg) * scale
        logits = torch.where(mask[None, None, :, :], logits, -1e9)
        attn = _softmax(logits, axis=-1)
        o = torch.einsum("bhsw,bhswd->bhsd", attn, vg)
        return (lambda x, *d: x.permute(*d))(o, 0, 2, 1, 3).reshape(B, S, D) @ wo

    def _B_ref(x, dft_seq_re, dft_seq_im, dft_hid_re, dft_hid_im):
        a = torch.einsum("bsd,ed->bse", x, dft_hid_re)
        b = torch.einsum("bsd,ed->bse", x, dft_hid_im)
        y = torch.einsum("ts,bse->bte", dft_seq_re, a) - torch.einsum("ts,bse->bte", dft_seq_im, b)
        return y

    x = A_x
    g = _sigmoid((x * gate_w).sum(-1, keepdims=True))
    a = _A_ref(x, A_wqkv, A_wo)
    b = _B_ref(x, B_dft_seq_re, B_dft_seq_im, B_dft_hid_re, B_dft_hid_im)
    return g * a + (1 - g) * b
```

```asm
; @launch kernel=k1_kernel grid=(256,1,1) block=(512,1,1) lds=161920
; @launch kernel=k2_kernel grid=(256,1,1) block=(512,1,1) lds=147456
.amdgcn_target "amdgcn-amd-amdhsa--gfx950"
.text
.globl k1_kernel
.p2align 8
.type k1_kernel,@function
k1_kernel:
    s_cmp_ge_u32 s2, 256
    s_cbranch_scc1 k1_kernel_end
    s_load_dwordx4 s[4:7], s[0:1], 0
    s_load_dwordx2 s[8:9], s[0:1], 16
    s_load_dwordx2 s[10:11], s[0:1], 64
    s_load_dwordx2 s[12:13], s[0:1], 88
    s_getpc_b64 s[14:15]
k1_kernel_pc:
    v_lshrrev_b32 v1, 6, v0
    v_and_b32 v0, 63, v0
    s_and_b32 s60, s2, 63
    v_readfirstlane_b32 s44, v1
    s_lshr_b32 s61, s2, 6
    s_mov_b32 s40, s14
    s_and_b32 s41, s15, 0xffff
    s_mov_b32 s42, code_end - k1_kernel_pc
    s_mov_b32 s43, 0x00020000
    s_cmp_lg_u32 s44, 0
    s_cbranch_scc1 k1_kernel_nocpf
    s_lshr_b32 s48, s2, 3
    s_and_b32 s48, s48, 7
    s_mul_i32 s48, s48, 2816
    v_lshlrev_b32 v51, 7, v0
    v_add_u32 v51, s48, v51
    s_mov_b64 exec, 4194303
    buffer_load_dword v51, v51, s[40:43], 0 offen
    s_mov_b64 exec, -1
k1_kernel_nocpf:
    v_lshrrev_b32 v5, 1, v0
    v_xor_b32 v5, s44, v5
    v_and_b32 v6, 1, v0
    v_lshlrev_b32 v6, 4, v6
    v_lshl_add_u32 v67, v5, 5, v6
    s_waitcnt lgkmcnt(0)
    s_mov_b32 s16, s4
    s_and_b32 s17, s5, 0xffff
    s_mov_b32 s18, 4194304
    s_mov_b32 s19, 0x00020000
    s_cmp_lg_u32 s44, 7
    s_cbranch_scc1 k1_kernel_nstlb
    s_mov_b32 s48, 0
    s_load_dword s70, s[6:7], s48
    s_mov_b32 s48, 2097152
    s_load_dword s70, s[6:7], s48
    s_mov_b32 s48, 4194304
    s_load_dword s70, s[6:7], s48
    s_load_dword s70, s[8:9], 0
    s_mov_b32 s48, 0
    s_load_dword s70, s[12:13], s48
    s_mov_b32 s48, 2097152
    s_load_dword s70, s[12:13], s48
    s_mov_b32 s48, 4194304
    s_load_dword s70, s[12:13], s48
    s_mov_b32 s48, 6291456
    s_load_dword s70, s[12:13], s48
    s_mov_b32 s48, 8388608
    s_load_dword s70, s[12:13], s48
    s_mov_b32 s48, 10485760
    s_load_dword s70, s[12:13], s48
    s_mov_b32 s48, 12582912
    s_load_dword s70, s[12:13], s48
k1_kernel_nstlb:
    s_cmp_lt_u32 s44, 4
    s_cbranch_scc1 k1_kernel_nogw
    s_mov_b32 s32, s10
    s_and_b32 s33, s11, 0xffff
    s_mov_b32 s34, 2048
    s_mov_b32 s35, 0x00020000
    v_lshlrev_b32 v5, 5, v0
    buffer_load_dwordx4 v[160:163], v5, s[32:35], 0 offen
    buffer_load_dwordx4 v[164:167], v5, s[32:35], 0 offen offset:16
k1_kernel_nogw:
    s_add_u32 s48, s61, 0
    s_and_b32 s48, s48, 3
    s_lshl_b32 s48, s48, 3
    s_add_u32 s48, s48, s44
    s_lshl_b32 s65, s48, 11
    s_add_u32 m0, s65, 43008
    s_lshl_b32 s65, s48, 6
    s_add_u32 s65, s65, s60
    s_lshl_b32 s65, s65, 11
    buffer_load_dwordx4 v67, s[16:19], s65 offen lds
    buffer_load_dwordx4 v67, s[16:19], s65 offen offset:1024 lds
    s_add_u32 s48, s61, 1
    s_and_b32 s48, s48, 3
    s_lshl_b32 s48, s48, 3
    s_add_u32 s48, s48, s44
    s_lshl_b32 s65, s48, 11
    s_add_u32 m0, s65, 43008
    s_lshl_b32 s65, s48, 6
    s_add_u32 s65, s65, s60
    s_lshl_b32 s65, s65, 11
    buffer_load_dwordx4 v67, s[16:19], s65 offen lds
    buffer_load_dwordx4 v67, s[16:19], s65 offen offset:1024 lds
    s_add_u32 s48, s61, 2
    s_and_b32 s48, s48, 3
    s_lshl_b32 s48, s48, 3
    s_add_u32 s48, s48, s44
    s_lshl_b32 s65, s48, 11
    s_add_u32 m0, s65, 43008
    s_lshl_b32 s65, s48, 6
    s_add_u32 s65, s65, s60
    s_lshl_b32 s65, s65, 11
    buffer_load_dwordx4 v67, s[16:19], s65 offen lds
    buffer_load_dwordx4 v67, s[16:19], s65 offen offset:1024 lds
    s_add_u32 s48, s61, 3
    s_and_b32 s48, s48, 3
    s_lshl_b32 s48, s48, 3
    s_add_u32 s48, s48, s44
    s_lshl_b32 s65, s48, 11
    s_add_u32 m0, s65, 43008
    s_lshl_b32 s65, s48, 6
    s_add_u32 s65, s65, s60
    s_lshl_b32 s65, s65, 11
    buffer_load_dwordx4 v67, s[16:19], s65 offen lds
    buffer_load_dwordx4 v67, s[16:19], s65 offen offset:1024 lds
    s_mov_b32 s20, s6
    s_and_b32 s21, s7, 0xffff
    s_mov_b32 s22, 6291456
    s_mov_b32 s23, 0x00020000
    s_and_b32 s48, s2, 7
    s_lshr_b32 s49, s2, 3
    s_and_b32 s45, s48, 1
    s_lshl_b32 s45, s45, 3
    s_and_b32 s50, s49, 7
    s_add_u32 s45, s45, s50
    s_lshr_b32 s46, s48, 1
    s_lshl_b32 s46, s46, 2
    s_lshr_b32 s50, s49, 3
    s_add_u32 s46, s46, s50
    s_lshl_b32 s47, s45, 7
    v_and_b32 v1, 15, v0
    v_lshrrev_b32 v2, 4, v0
    v_lshrrev_b32 v3, 2, v1
    v_and_b32 v4, 3, v1
    v_lshlrev_b32 v5, 2, v2
    v_cvt_f32_u32 v52, v5
    v_add_f32 v53, 1065353216, v52
    v_add_f32 v54, 1073741824, v52
    v_add_f32 v55, 1077936128, v52
    v_add_f32 v56, 1098907648, v52
    v_add_f32 v57, 1099431936, v52
    v_add_f32 v58, 1099956224, v52
    v_add_f32 v59, 1100480512, v52
    v_lshrrev_b32 v5, 1, v1
    s_lshl_b32 s48, s61, 3
    v_add_u32 v5, s48, v5
    v_cvt_f32_u32 v5, v5
    v_mul_f32 v5, 1023410176, v5
    v_and_b32 v6, 1, v1
    v_cvt_f32_u32 v6, v6
    v_mul_f32 v6, 1048576000, v6
    v_fma_f32 v80, v5, v52, v6
    v_fma_f32 v81, v5, v53, v6
    v_fma_f32 v82, v5, v54, v6
    v_fma_f32 v83, v5, v55, v6
    v_fma_f32 v84, v5, v56, v6
    v_fma_f32 v85, v5, v57, v6
    v_fma_f32 v86, v5, v58, v6
    v_fma_f32 v87, v5, v59, v6
    v_cos_f32 v80, v80
    v_cos_f32 v81, v81
    v_cos_f32 v82, v82
    v_cos_f32 v83, v83
    v_cos_f32 v84, v84
    v_cos_f32 v85, v85
    v_cos_f32 v86, v86
    v_cos_f32 v87, v87
    v_lshl_add_u32 v5, v2, 2, v3
    v_lshlrev_b32 v64, 11, v5
    v_and_b32 v6, 7, v5
    v_lshl_add_u32 v64, v6, 5, v64
    v_lshl_add_u32 v64, v4, 3, v64
    s_lshl_b32 s48, s44, 8
    v_add_u32 v64, s48, v64
    v_mul_u32_u24 v65, 2056, v1
    v_lshl_add_u32 v65, v2, 3, v65
    s_and_b32 s49, s44, 1
    s_lshl_b32 s49, s49, 5
    s_add_u32 s48, s48, 129024
    s_add_u32 s50, s48, s49
    s_xor_b32 s49, s49, 32
    s_add_u32 s49, s48, s49
    v_add_u32 v66, s49, v65
    v_add_u32 v65, s50, v65
    v_cvt_pk_bf16_f32 v60, v80, v81
    v_cvt_pk_bf16_f32 v61, v82, v83
    v_cvt_pk_bf16_f32 v62, v84, v85
    v_cvt_pk_bf16_f32 v63, v86, v87
    v_add_u32 v64, 43008, v64
    v_xor_b32 v68, 32, v64
    v_xor_b32 v69, 64, v64
    v_xor_b32 v70, 96, v64
    v_xor_b32 v71, 128, v64
    v_xor_b32 v72, 160, v64
    v_xor_b32 v73, 192, v64
    v_xor_b32 v74, 224, v64
    s_cmp_lt_u32 s44, 4
    s_cbranch_scc1 k1_kernel_compute
    s_add_u32 s36, s12, 12582912
    s_addc_u32 s37, s13, 0
    s_and_b32 s37, s37, 0xffff
    s_mov_b32 s38, 8192
    s_mov_b32 s39, 0x00020000
    s_sub_u32 s57, s44, 4
    v_lshrrev_b32 v8, 3, v0
    v_and_b32 v9, 7, v0
    s_lshl_b32 s48, s61, 3
    s_lshl_b32 s49, s57, 1
    s_add_u32 s51, s48, s49
    v_xor_b32 v5, s49, v0
    v_lshlrev_b32 v20, 5, v5
    v_xor_b32 v21, 32, v20
    s_lshl_b32 s48, s51, 11
    s_add_u32 s48, s48, 43008
    v_add_u32 v20, s48, v20
    s_add_u32 s48, s48, 2048
    v_add_u32 v21, s48, v21
    s_lshl_b32 s51, s51, 6
    s_add_u32 s51, s51, s60
    s_lshl_b32 s51, s51, 2
    v_mul_u32_u24 v5, 6144, v8
    s_lshl_b32 s48, s46, 7
    s_lshl_b32 s49, s57, 11
    s_add_u32 s48, s48, s49
    v_add_u32 v5, s48, v5
    v_and_b32 v6, 2, v8
    v_xor_b32 v6, v6, v9
    v_lshl_add_u32 v16, v6, 4, v5
    v_xor_b32 v6, 4, v6
    v_lshl_add_u32 v17, v6, 4, v5
    v_add_u32 v17, 48128, v17
    v_add_u32 v18, 96256, v16
    v_add_u32 v19, 96256, v17
    s_mov_b32 s68, 1076895760
    s_mov_b32 s69, 8465
    s_cmp_eq_u32 s57, 1
    s_cselect_b32 s68, 1615872305, s68
    s_cselect_b32 s69, 32880, s69
    s_cmp_eq_u32 s57, 2
    s_cselect_b32 s68, 2171691345, s68
    s_cselect_b32 s69, 256, s69
    v_lshlrev_b32 v5, 12, v8
    v_xor_b32 v6, v9, v8
    v_lshl_add_u32 v5, v6, 4, v5
    s_sub_u32 s49, s47, 16
    s_bfe_u32 s48, s68, 524288
    s_add_u32 s48, s48, s49
    s_lshl_b32 s48, s48, 11
    s_sub_u32 s48, s48, 0
    v_add_u32 v10, s48, v5
    s_bfe_u32 s48, s68, 524296
    s_add_u32 s48, s48, s49
    s_lshl_b32 s48, s48, 11
    s_sub_u32 s48, s48, 1024
    v_add_u32 v11, s48, v5
    s_bfe_u32 s48, s68, 524304
    s_add_u32 s48, s48, s49
    s_lshl_b32 s48, s48, 11
    s_sub_u32 s48, s48, 2048
    v_add_u32 v12, s48, v5
    s_bfe_u32 s48, s68, 524312
    s_add_u32 s48, s48, s49
    s_lshl_b32 s48, s48, 11
    s_sub_u32 s48, s48, 3072
    v_add_u32 v13, s48, v5
    s_bfe_u32 s48, s69, 524288
    s_add_u32 s48, s48, s49
    s_lshl_b32 s48, s48, 11
    s_sub_u32 s48, s48, 0
    v_add_u32 v14, s48, v5
    s_bfe_u32 s48, s69, 524296
    s_add_u32 s48, s48, s49
    s_lshl_b32 s48, s48, 11
    s_sub_u32 s48, s48, 1024
    v_add_u32 v15, s48, v5
    s_mul_i32 s66, s57, 6144
    s_lshl_b32 s67, s57, 13
    s_add_u32 s67, s67, 18432
    s_mov_b32 s52, 0
    s_mov_b32 s53, 0
    s_mov_b32 s54, 196608
    s_mov_b32 s56, 0
    s_waitcnt vmcnt(0) lgkmcnt(0)
    s_barrier
    ds_read_b64_tr_b16 v[96:97], v64 offset:0
    ds_read_b64_tr_b16 v[98:99], v64 offset:32768
    ds_read_b64_tr_b16 v[100:101], v68 offset:0
    ds_read_b64_tr_b16 v[102:103], v68 offset:32768
    ds_read_b64_tr_b16 v[104:105], v69 offset:0
    ds_read_b64_tr_b16 v[106:107], v69 offset:32768
    ds_read_b64_tr_b16 v[108:109], v70 offset:0
    ds_read_b64_tr_b16 v[110:111], v70 offset:32768
    ds_read_b64_tr_b16 v[112:113], v71 offset:0
    ds_read_b64_tr_b16 v[114:115], v71 offset:32768
    ds_read_b64_tr_b16 v[116:117], v72 offset:0
    ds_read_b64_tr_b16 v[118:119], v72 offset:32768
    ds_read_b64_tr_b16 v[120:121], v73 offset:0
    ds_read_b64_tr_b16 v[122:123], v73 offset:32768
    ds_read_b64_tr_b16 v[124:125], v74 offset:0
    ds_read_b64_tr_b16 v[126:127], v74 offset:32768
    ds_read_b128 v[168:171], v20
    ds_read_b128 v[172:175], v20 offset:16
    ds_read_b128 v[176:179], v21
    ds_read_b128 v[180:183], v21 offset:16
    s_waitcnt lgkmcnt(15)
    v_mfma_f32_16x16x32_bf16 v[128:131], v[96:99], v[60:63], 0
    s_waitcnt lgkmcnt(15)
    v_mfma_f32_16x16x32_bf16 v[132:135], v[100:103], v[60:63], 0
    s_waitcnt lgkmcnt(14)
    v_mfma_f32_16x16x32_bf16 v[136:139], v[104:107], v[60:63], 0
    s_waitcnt lgkmcnt(12)
    v_mfma_f32_16x16x32_bf16 v[140:143], v[108:111], v[60:63], 0
    s_waitcnt lgkmcnt(10)
    v_mfma_f32_16x16x32_bf16 v[144:147], v[112:115], v[60:63], 0
    s_waitcnt lgkmcnt(8)
    v_mfma_f32_16x16x32_bf16 v[148:151], v[116:119], v[60:63], 0
    s_waitcnt lgkmcnt(6)
    v_mfma_f32_16x16x32_bf16 v[152:155], v[120:123], v[60:63], 0
    s_waitcnt lgkmcnt(4)
    v_mfma_f32_16x16x32_bf16 v[156:159], v[124:127], v[60:63], 0
    s_nop 3
    v_cvt_pk_bf16_f32 v128, v128, v129
    v_cvt_pk_bf16_f32 v129, v130, v131
    ds_write_b64 v65, v[128:129] offset:0
    v_cvt_pk_bf16_f32 v132, v132, v133
    v_cvt_pk_bf16_f32 v133, v134, v135
    ds_write_b64 v66, v[132:133] offset:0
    v_cvt_pk_bf16_f32 v136, v136, v137
    v_cvt_pk_bf16_f32 v137, v138, v139
    ds_write_b64 v65, v[136:137] offset:64
    v_cvt_pk_bf16_f32 v140, v140, v141
    v_cvt_pk_bf16_f32 v141, v142, v143
    ds_write_b64 v66, v[140:141] offset:64
    v_cvt_pk_bf16_f32 v144, v144, v145
    v_cvt_pk_bf16_f32 v145, v146, v147
    ds_write_b64 v65, v[144:145] offset:128
    v_cvt_pk_bf16_f32 v148, v148, v149
    v_cvt_pk_bf16_f32 v149, v150, v151
    ds_write_b64 v66, v[148:149] offset:128
    v_cvt_pk_bf16_f32 v152, v152, v153
    v_cvt_pk_bf16_f32 v153, v154, v155
    ds_write_b64 v65, v[152:153] offset:192
    v_cvt_pk_bf16_f32 v156, v156, v157
    v_cvt_pk_bf16_f32 v157, v158, v159
    ds_write_b64 v66, v[156:157] offset:192
    s_waitcnt lgkmcnt(0)
    s_barrier
    v_mov_b32 v22, 0
    v_mov_b32 v23, 0
    v_lshlrev_b32 v82, 16, v160
    v_and_b32 v83, 0xffff0000, v160
    v_lshlrev_b32 v84, 16, v168
    v_and_b32 v85, 0xffff0000, v168
    v_mul_f32 v84, v84, v82
    v_mul_f32 v85, v85, v83
    v_cvt_pk_bf16_f32 v84, 0, v84
    v_cvt_pk_bf16_f32 v85, 0, v85
    v_add_f32 v22, v22, v84
    v_add_f32 v22, v22, v85
    v_lshlrev_b32 v88, 16, v176
    v_and_b32 v89, 0xffff0000, v176
    v_mul_f32 v88, v88, v82
    v_mul_f32 v89, v89, v83
    v_cvt_pk_bf16_f32 v88, 0, v88
    v_cvt_pk_bf16_f32 v89, 0, v89
    v_add_f32 v23, v23, v88
    v_add_f32 v23, v23, v89
    v_lshlrev_b32 v82, 16, v161
    v_and_b32 v83, 0xffff0000, v161
    v_lshlrev_b32 v84, 16, v169
    v_and_b32 v85, 0xffff0000, v169
    v_mul_f32 v84, v84, v82
    v_mul_f32 v85, v85, v83
    v_cvt_pk_bf16_f32 v84, 0, v84
    v_cvt_pk_bf16_f32 v85, 0, v85
    v_add_f32 v22, v22, v84
    v_add_f32 v22, v22, v85
    v_lshlrev_b32 v88, 16, v177
    v_and_b32 v89, 0xffff0000, v177
    v_mul_f32 v88, v88, v82
    v_mul_f32 v89, v89, v83
    v_cvt_pk_bf16_f32 v88, 0, v88
    v_cvt_pk_bf16_f32 v89, 0, v89
    v_add_f32 v23, v23, v88
    v_add_f32 v23, v23, v89
    v_lshlrev_b32 v82, 16, v162
    v_and_b32 v83, 0xffff0000, v162
    v_lshlrev_b32 v84, 16, v170
    v_and_b32 v85, 0xffff0000, v170
    v_mul_f32 v84, v84, v82
    v_mul_f32 v85, v85, v83
    v_cvt_pk_bf16_f32 v84, 0, v84
    v_cvt_pk_bf16_f32 v85, 0, v85
    v_add_f32 v22, v22, v84
    v_add_f32 v22, v22, v85
    v_lshlrev_b32 v88, 16, v178
    v_and_b32 v89, 0xffff0000, v178
    v_mul_f32 v88, v88, v82
    v_mul_f32 v89, v89, v83
    v_cvt_pk_bf16_f32 v88, 0, v88
    v_cvt_pk_bf16_f32 v89, 0, v89
    v_add_f32 v23, v23, v88
    v_add_f32 v23, v23, v89
    v_lshlrev_b32 v82, 16, v163
    v_and_b32 v83, 0xffff0000, v163
    v_lshlrev_b32 v84, 16, v171
    v_and_b32 v85, 0xffff0000, v171
    v_mul_f32 v84, v84, v82
    v_mul_f32 v85, v85, v83
    v_cvt_pk_bf16_f32 v84, 0, v84
    v_cvt_pk_bf16_f32 v85, 0, v85
    v_add_f32 v22, v22, v84
    v_add_f32 v22, v22, v85
    v_lshlrev_b32 v88, 16, v179
    v_and_b32 v89, 0xffff0000, v179
    v_mul_f32 v88, v88, v82
    v_mul_f32 v89, v89, v83
    v_cvt_pk_bf16_f32 v88, 0, v88
    v_cvt_pk_bf16_f32 v89, 0, v89
    v_add_f32 v23, v23, v88
    v_add_f32 v23, v23, v89
    v_lshlrev_b32 v82, 16, v164
    v_and_b32 v83, 0xffff0000, v164
    v_lshlrev_b32 v84, 16, v172
    v_and_b32 v85, 0xffff0000, v172
    v_mul_f32 v84, v84, v82
    v_mul_f32 v85, v85, v83
    v_cvt_pk_bf16_f32 v84, 0, v84
    v_cvt_pk_bf16_f32 v85, 0, v85
    v_add_f32 v22, v22, v84
    v_add_f32 v22, v22, v85
    v_lshlrev_b32 v88, 16, v180
    v_and_b32 v89, 0xffff0000, v180
    v_mul_f32 v88, v88, v82
    v_mul_f32 v89, v89, v83
    v_cvt_pk_bf16_f32 v88, 0, v88
    v_cvt_pk_bf16_f32 v89, 0, v89
    v_add_f32 v23, v23, v88
    v_add_f32 v23, v23, v89
    v_lshlrev_b32 v82, 16, v165
    v_and_b32 v83, 0xffff0000, v165
    v_lshlrev_b32 v84, 16, v173
    v_and_b32 v85, 0xffff0000, v173
    v_mul_f32 v84, v84, v82
    v_mul_f32 v85, v85, v83
    v_cvt_pk_bf16_f32 v84, 0, v84
    v_cvt_pk_bf16_f32 v85, 0, v85
    v_add_f32 v22, v22, v84
    v_add_f32 v22, v22, v85
    v_lshlrev_b32 v88, 16, v181
    v_and_b32 v89, 0xffff0000, v181
    v_mul_f32 v88, v88, v82
    v_mul_f32 v89, v89, v83
    v_cvt_pk_bf16_f32 v88, 0, v88
    v_cvt_pk_bf16_f32 v89, 0, v89
    v_add_f32 v23, v23, v88
    v_add_f32 v23, v23, v89
    v_lshlrev_b32 v82, 16, v166
    v_and_b32 v83, 0xffff0000, v166
    v_lshlrev_b32 v84, 16, v174
    v_and_b32 v85, 0xffff0000, v174
    v_mul_f32 v84, v84, v82
    v_mul_f32 v85, v85, v83
    v_cvt_pk_bf16_f32 v84, 0, v84
    v_cvt_pk_bf16_f32 v85, 0, v85
    v_add_f32 v22, v22, v84
    v_add_f32 v22, v22, v85
    v_lshlrev_b32 v88, 16, v182
    v_and_b32 v89, 0xffff0000, v182
    v_mul_f32 v88, v88, v82
    v_mul_f32 v89, v89, v83
    v_cvt_pk_bf16_f32 v88, 0, v88
    v_cvt_pk_bf16_f32 v89, 0, v89
    v_add_f32 v23, v23, v88
    v_add_f32 v23, v23, v89
    v_lshlrev_b32 v82, 16, v167
    v_and_b32 v83, 0xffff0000, v167
    v_lshlrev_b32 v84, 16, v175
    v_and_b32 v85, 0xffff0000, v175
    v_mul_f32 v84, v84, v82
    v_mul_f32 v85, v85, v83
    v_cvt_pk_bf16_f32 v84, 0, v84
    v_cvt_pk_bf16_f32 v85, 0, v85
    v_add_f32 v22, v22, v84
    v_add_f32 v22, v22, v85
    v_lshlrev_b32 v88, 16, v183
    v_and_b32 v89, 0xffff0000, v183
    v_mul_f32 v88, v88, v82
    v_mul_f32 v89, v89, v83
    v_cvt_pk_bf16_f32 v88, 0, v88
    v_cvt_pk_bf16_f32 v89, 0, v89
    v_add_f32 v23, v23, v88
    v_add_f32 v23, v23, v89
    s_nop 1
    v_add_f32_dpp v22, v22, v22 row_ror:8 row_mask:0xf bank_mask:0xf
    v_add_f32_dpp v23, v23, v23 row_ror:8 row_mask:0xf bank_mask:0xf
    s_nop 1
    v_add_f32_dpp v22, v22, v22 row_ror:4 row_mask:0xf bank_mask:0xf
    v_add_f32_dpp v23, v23, v23 row_ror:4 row_mask:0xf bank_mask:0xf
    s_nop 1
    v_add_f32_dpp v22, v22, v22 row_ror:2 row_mask:0xf bank_mask:0xf
    v_add_f32_dpp v23, v23, v23 row_ror:2 row_mask:0xf bank_mask:0xf
    s_nop 1
    v_add_f32_dpp v22, v22, v22 row_ror:1 row_mask:0xf bank_mask:0xf
    v_add_f32_dpp v23, v23, v23 row_ror:1 row_mask:0xf bank_mask:0xf
    v_mov_b32 v80, v22
    v_mov_b32 v81, v23
    s_nop 1
    v_permlane32_swap_b32 v22, v80
    v_permlane32_swap_b32 v23, v81
    s_nop 1
    v_add_f32 v22, v22, v80
    v_add_f32 v23, v23, v81
    v_mov_b32 v80, v22
    v_mov_b32 v81, v23
    s_nop 1
    v_permlane16_swap_b32 v22, v80
    v_permlane16_swap_b32 v23, v81
    s_nop 1
    v_add_f32 v22, v22, v80
    v_add_f32 v23, v23, v81
    v_cvt_pk_bf16_f32 v22, 0, v22
    v_mul_f32 v22, 3216550459, v22
    v_exp_f32 v22, v22
    s_nop 0
    v_add_f32 v22, 1.0, v22
    v_rcp_f32 v22, v22
    s_nop 0
    v_cvt_pk_bf16_f32 v22, 0, v22
    v_cvt_pk_bf16_f32 v23, 0, v23
    v_mul_f32 v23, 3216550459, v23
    v_exp_f32 v23, v23
    s_nop 0
    v_add_f32 v23, 1.0, v23
    v_rcp_f32 v23, v23
    s_nop 0
    v_cvt_pk_bf16_f32 v23, 0, v23
    s_cmp_eq_u32 s57, 3
    s_cbranch_scc1 k1_kernel_misc
    s_add_u32 m0, s67, s56
    s_add_u32 s48, s67, s56
    buffer_load_dwordx4 v16, s[20:23], s53 offen offset:0 lds
    buffer_load_dwordx4 v17, s[20:23], s53 offen offset:1024 lds
    buffer_load_dwordx4 v18, s[20:23], s53 offen offset:2048 lds
    buffer_load_dwordx4 v19, s[20:23], s53 offen offset:3072 lds
    s_add_u32 m0, s66, s56
    s_add_u32 s49, s66, s56
    buffer_load_dwordx4 v10, s[16:19], s52 offen offset:0 lds
    buffer_load_dwordx4 v11, s[16:19], s52 offen offset:1024 lds
    buffer_load_dwordx4 v12, s[16:19], s52 offen offset:2048 lds
    buffer_load_dwordx4 v13, s[16:19], s52 offen offset:3072 lds
    s_add_u32 m0, s49, 4096
    s_add_u32 s53, s53, 393216
    buffer_load_dwordx4 v14, s[16:19], s52 offen offset:0 lds
    buffer_load_dwordx4 v15, s[16:19], s52 offen offset:1024 lds
    s_add_u32 m0, s48, 4096
    s_add_u32 s52, s52, 128
    buffer_load_dwordx4 v16, s[20:23], s54 offen offset:0 lds
    buffer_load_dwordx4 v17, s[20:23], s54 offen offset:1024 lds
    buffer_load_dwordx4 v18, s[20:23], s54 offen offset:2048 lds
    buffer_load_dwordx4 v19, s[20:23], s54 offen offset:3072 lds
    s_add_u32 s54, s54, 393216
    s_add_u32 s56, s56, 43008
    s_cmp_eq_u32 s56, 129024
    s_cselect_b32 s56, 0, s56
    s_add_u32 m0, s67, s56
    s_add_u32 s48, s67, s56
    buffer_load_dwordx4 v16, s[20:23], s53 offen offset:0 lds
    buffer_load_dwordx4 v17, s[20:23], s53 offen offset:1024 lds
    buffer_load_dwordx4 v18, s[20:23], s53 offen offset:2048 lds
    buffer_load_dwordx4 v19, s[20:23], s53 offen offset:3072 lds
    s_add_u32 m0, s66, s56
    s_add_u32 s49, s66, s56
    buffer_load_dwordx4 v10, s[16:19], s52 offen offset:0 lds
    buffer_load_dwordx4 v11, s[16:19], s52 offen offset:1024 lds
    buffer_load_dwordx4 v12, s[16:19], s52 offen offset:2048 lds
    buffer_load_dwordx4 v13, s[16:19], s52 offen offset:3072 lds
    s_add_u32 m0, s49, 4096
    s_add_u32 s53, s53, 393216
    buffer_load_dwordx4 v14, s[16:19], s52 offen offset:0 lds
    buffer_load_dwordx4 v15, s[16:19], s52 offen offset:1024 lds
    s_add_u32 m0, s48, 4096
    s_add_u32 s52, s52, 128
    buffer_load_dwordx4 v16, s[20:23], s54 offen offset:0 lds
    buffer_load_dwordx4 v17, s[20:23], s54 offen offset:1024 lds
    buffer_load_dwordx4 v18, s[20:23], s54 offen offset:2048 lds
    buffer_load_dwordx4 v19, s[20:23], s54 offen offset:3072 lds
    s_add_u32 s54, s54, 393216
    s_add_u32 s56, s56, 43008
    s_cmp_eq_u32 s56, 129024
    s_cselect_b32 s56, 0, s56
    s_waitcnt vmcnt(14)
    s_barrier
    s_add_u32 m0, s67, s56
    s_add_u32 s48, s67, s56
    buffer_load_dwordx4 v16, s[20:23], s53 offen offset:0 lds
    buffer_load_dwordx4 v17, s[20:23], s53 offen offset:1024 lds
    buffer_load_dwordx4 v18, s[20:23], s53 offen offset:2048 lds
    buffer_load_dwordx4 v19, s[20:23], s53 offen offset:3072 lds
    s_add_u32 m0, s66, s56
    s_add_u32 s49, s66, s56
    buffer_load_dwordx4 v10, s[16:19], s52 offen offset:0 lds
    buffer_load_dwordx4 v11, s[16:19], s52 offen offset:1024 lds
    buffer_load_dwordx4 v12, s[16:19], s52 offen offset:2048 lds
    buffer_load_dwordx4 v13, s[16:19], s52 offen offset:3072 lds
    s_add_u32 m0, s49, 4096
    s_add_u32 s53, s53, 393216
    buffer_load_dwordx4 v14, s[16:19], s52 offen offset:0 lds
    buffer_load_dwordx4 v15, s[16:19], s52 offen offset:1024 lds
    s_add_u32 m0, s48, 4096
    s_add_u32 s52, s52, 128
    buffer_load_dwordx4 v16, s[20:23], s54 offen offset:0 lds
    buffer_load_dwordx4 v17, s[20:23], s54 offen offset:1024 lds
    buffer_load_dwordx4 v18, s[20:23], s54 offen offset:2048 lds
    buffer_load_dwordx4 v19, s[20:23], s54 offen offset:3072 lds
    s_add_u32 s54, s54, 393216
    s_add_u32 s56, s56, 43008
    s_cmp_eq_u32 s56, 129024
    s_cselect_b32 s56, 0, s56
    s_mov_b32 s55, 0
k1_kernel_lloop:
    s_waitcnt vmcnt(14)
    s_barrier
    s_add_u32 m0, s67, s56
    s_add_u32 s48, s67, s56
    buffer_load_dwordx4 v16, s[20:23], s53 offen offset:0 lds
    buffer_load_dwordx4 v17, s[20:23], s53 offen offset:1024 lds
    buffer_load_dwordx4 v18, s[20:23], s53 offen offset:2048 lds
    buffer_load_dwordx4 v19, s[20:23], s53 offen offset:3072 lds
    s_add_u32 m0, s66, s56
    s_add_u32 s49, s66, s56
    buffer_load_dwordx4 v10, s[16:19], s52 offen offset:0 lds
    buffer_load_dwordx4 v11, s[16:19], s52 offen offset:1024 lds
    buffer_load_dwordx4 v12, s[16:19], s52 offen offset:2048 lds
    buffer_load_dwordx4 v13, s[16:19], s52 offen offset:3072 lds
    s_add_u32 m0, s49, 4096
    s_add_u32 s53, s53, 393216
    buffer_load_dwordx4 v14, s[16:19], s52 offen offset:0 lds
    buffer_load_dwordx4 v15, s[16:19], s52 offen offset:1024 lds
    s_add_u32 m0, s48, 4096
    s_add_u32 s52, s52, 128
    buffer_load_dwordx4 v16, s[20:23], s54 offen offset:0 lds
    buffer_load_dwordx4 v17, s[20:23], s54 offen offset:1024 lds
    buffer_load_dwordx4 v18, s[20:23], s54 offen offset:2048 lds
    buffer_load_dwordx4 v19, s[20:23], s54 offen offset:3072 lds
    s_add_u32 s54, s54, 393216
    s_add_u32 s56, s56, 43008
    s_cmp_eq_u32 s56, 129024
    s_cselect_b32 s56, 0, s56
    s_add_u32 s55, s55, 1
    s_cmp_lt_u32 s55, 13
    s_cbranch_scc1 k1_kernel_lloop
    s_waitcnt vmcnt(14)
    s_barrier
    s_waitcnt vmcnt(0)
    s_barrier
    v_mov_b32 v80, s51
    s_mov_b64 exec, 1
    buffer_store_dword v22, v80, s[36:39], 0 offen
    buffer_store_dword v23, v80, s[36:39], 0 offen offset:256
    s_mov_b64 exec, -1
    s_barrier
    s_barrier
    s_branch k1_kernel_end
k1_kernel_misc:
    v_mov_b32 v80, s51
    s_mov_b64 exec, 1
    buffer_store_dword v22, v80, s[36:39], 0 offen
    buffer_store_dword v23, v80, s[36:39], 0 offen offset:256
    s_mov_b64 exec, -1
    s_add_u32 s28, s12, 4194304
    s_addc_u32 s29, s13, 0
    s_and_b32 s29, s29, 0xffff
    s_mov_b32 s30, 8388608
    s_mov_b32 s31, 0x00020000
    s_mov_b32 s32, s8
    s_and_b32 s33, s9, 0xffff
    s_mov_b32 s34, 2097152
    s_mov_b32 s35, 0x00020000
    s_lshl_b32 s49, s61, 10
    s_add_u32 s49, s49, s60
    s_lshl_b32 s49, s49, 11
    v_lshlrev_b32 v26, 4, v0
    v_add_u32 v26, s49, v26
    v_bfe_u32 v5, v0, 3, 1
    v_bfe_u32 v6, v0, 5, 1
    v_lshl_add_u32 v5, v6, 1, v5
    v_xor_b32 v5, v5, v0
    v_lshlrev_b32 v27, 4, v5
    v_add_u32 v27, 129024, v27
    s_lshr_b32 s48, s2, 3
    s_lshl_b32 s48, s48, 16
    v_lshlrev_b32 v24, 7, v0
    v_add_u32 v24, s48, v24
    s_load_dwordx2 s[24:25], s[0:1], 72
    s_waitcnt lgkmcnt(0)
    s_load_dword s70, s[24:25], 0
    s_mov_b32 s48, 2097152
    s_load_dword s70, s[24:25], s48
    s_waitcnt lgkmcnt(0)
    s_lshr_b32 s48, s2, 3
    s_lshl_b32 s48, s48, 16
    v_lshlrev_b32 v24, 11, v8
    v_lshl_add_u32 v24, v9, 7, v24
    s_bfe_u32 s49, s2, 65538
    s_lshl_b32 s49, s49, 10
    s_add_u32 s48, s48, s49
    v_add_u32 v24, s48, v24
    s_barrier
    s_barrier
    s_barrier
    s_barrier
    s_barrier
    s_barrier
    s_lshl_b32 s48, s2, 13
    v_lshlrev_b32 v5, 7, v0
    buffer_load_dword v6, v5, s[32:35], s48 offen
    s_barrier
    s_barrier
    s_barrier
    s_barrier
    s_barrier
    s_barrier
    s_barrier
    s_barrier
    ds_read_b128 v[96:99], v27 offset:0
    ds_read_b128 v[100:103], v27 offset:1024
    ds_read_b128 v[104:107], v27 offset:2048
    ds_read_b128 v[108:111], v27 offset:3072
    ds_read_b128 v[112:115], v27 offset:4096
    ds_read_b128 v[116:119], v27 offset:5120
    ds_read_b128 v[120:123], v27 offset:6144
    ds_read_b128 v[124:127], v27 offset:7168
    s_mov_b32 s48, 0
    s_waitcnt lgkmcnt(7)
    buffer_store_dwordx4 v[96:99], v26, s[28:31], s48 offen offset:0 sc1
    s_mov_b32 s48, 0
    s_waitcnt lgkmcnt(6)
    buffer_store_dwordx4 v[100:103], v26, s[28:31], s48 offen offset:1024 sc1
    s_mov_b32 s48, 131072
    s_waitcnt lgkmcnt(5)
    buffer_store_dwordx4 v[104:107], v26, s[28:31], s48 offen offset:0 sc1
    s_mov_b32 s48, 131072
    s_waitcnt lgkmcnt(4)
    buffer_store_dwordx4 v[108:111], v26, s[28:31], s48 offen offset:1024 sc1
    s_mov_b32 s48, 262144
    s_waitcnt lgkmcnt(3)
    buffer_store_dwordx4 v[112:115], v26, s[28:31], s48 offen offset:0 sc1
    s_mov_b32 s48, 262144
    s_waitcnt lgkmcnt(2)
    buffer_store_dwordx4 v[116:119], v26, s[28:31], s48 offen offset:1024 sc1
    s_mov_b32 s48, 393216
    s_waitcnt lgkmcnt(1)
    buffer_store_dwordx4 v[120:123], v26, s[28:31], s48 offen offset:0 sc1
    s_mov_b32 s48, 393216
    s_waitcnt lgkmcnt(0)
    buffer_store_dwordx4 v[124:127], v26, s[28:31], s48 offen offset:1024 sc1
    s_barrier
    ds_read_b128 v[96:99], v27 offset:8224
    ds_read_b128 v[100:103], v27 offset:9248
    ds_read_b128 v[104:107], v27 offset:10272
    ds_read_b128 v[108:111], v27 offset:11296
    ds_read_b128 v[112:115], v27 offset:12320
    ds_read_b128 v[116:119], v27 offset:13344
    ds_read_b128 v[120:123], v27 offset:14368
    ds_read_b128 v[124:127], v27 offset:15392
    s_mov_b32 s48, 524288
    s_waitcnt lgkmcnt(7)
    buffer_store_dwordx4 v[96:99], v26, s[28:31], s48 offen offset:0 sc1
    s_mov_b32 s48, 524288
    s_waitcnt lgkmcnt(6)
    buffer_store_dwordx4 v[100:103], v26, s[28:31], s48 offen offset:1024 sc1
    s_mov_b32 s48, 655360
    s_waitcnt lgkmcnt(5)
    buffer_store_dwordx4 v[104:107], v26, s[28:31], s48 offen offset:0 sc1
    s_mov_b32 s48, 655360
    s_waitcnt lgkmcnt(4)
    buffer_store_dwordx4 v[108:111], v26, s[28:31], s48 offen offset:1024 sc1
    s_mov_b32 s48, 786432
    s_waitcnt lgkmcnt(3)
    buffer_store_dwordx4 v[112:115], v26, s[28:31], s48 offen offset:0 sc1
    s_mov_b32 s48, 786432
    s_waitcnt lgkmcnt(2)
    buffer_store_dwordx4 v[116:119], v26, s[28:31], s48 offen offset:1024 sc1
    s_mov_b32 s48, 917504
    s_waitcnt lgkmcnt(1)
    buffer_store_dwordx4 v[120:123], v26, s[28:31], s48 offen offset:0 sc1
    s_mov_b32 s48, 917504
    s_waitcnt lgkmcnt(0)
    buffer_store_dwordx4 v[124:127], v26, s[28:31], s48 offen offset:1024 sc1
    s_mov_b32 s48, 0
    buffer_load_dword v25, v24, s[32:35], s48 offen
    s_mov_b32 s48, 16384
    buffer_load_dword v25, v24, s[32:35], s48 offen
    s_mov_b32 s48, 32768
    buffer_load_dword v25, v24, s[32:35], s48 offen
    s_mov_b32 s48, 49152
    buffer_load_dword v25, v24, s[32:35], s48 offen
    s_lshr_b32 s48, s2, 3
    s_and_b32 s48, s48, 7
    s_mul_i32 s48, s48, 2816
    v_lshlrev_b32 v51, 7, v0
    v_add_u32 v51, s48, v51
    s_mov_b64 exec, 4194303
    buffer_load_dword v51, v51, s[40:43], 0 offen
    s_mov_b64 exec, -1
    s_barrier
    ds_read_b128 v[96:99], v27 offset:16448
    ds_read_b128 v[100:103], v27 offset:17472
    ds_read_b128 v[104:107], v27 offset:18496
    ds_read_b128 v[108:111], v27 offset:19520
    ds_read_b128 v[112:115], v27 offset:20544
    ds_read_b128 v[116:119], v27 offset:21568
    ds_read_b128 v[120:123], v27 offset:22592
    ds_read_b128 v[124:127], v27 offset:23616
    s_mov_b32 s48, 1048576
    s_waitcnt lgkmcnt(7)
    buffer_store_dwordx4 v[96:99], v26, s[28:31], s48 offen offset:0 sc1
    s_mov_b32 s48, 1048576
    s_waitcnt lgkmcnt(6)
    buffer_store_dwordx4 v[100:103], v26, s[28:31], s48 offen offset:1024 sc1
    s_mov_b32 s48, 1179648
    s_waitcnt lgkmcnt(5)
    buffer_store_dwordx4 v[104:107], v26, s[28:31], s48 offen offset:0 sc1
    s_mov_b32 s48, 1179648
    s_waitcnt lgkmcnt(4)
    buffer_store_dwordx4 v[108:111], v26, s[28:31], s48 offen offset:1024 sc1
    s_mov_b32 s48, 1310720
    s_waitcnt lgkmcnt(3)
    buffer_store_dwordx4 v[112:115], v26, s[28:31], s48 offen offset:0 sc1
    s_mov_b32 s48, 1310720
    s_waitcnt lgkmcnt(2)
    buffer_store_dwordx4 v[116:119], v26, s[28:31], s48 offen offset:1024 sc1
    s_mov_b32 s48, 1441792
    s_waitcnt lgkmcnt(1)
    buffer_store_dwordx4 v[120:123], v26, s[28:31], s48 offen offset:0 sc1
    s_mov_b32 s48, 1441792
    s_waitcnt lgkmcnt(0)
    buffer_store_dwordx4 v[124:127], v26, s[28:31], s48 offen offset:1024 sc1
    s_barrier
    ds_read_b128 v[96:99], v27 offset:24672
    ds_read_b128 v[100:103], v27 offset:25696
    ds_read_b128 v[104:107], v27 offset:26720
    ds_read_b128 v[108:111], v27 offset:27744
    ds_read_b128 v[112:115], v27 offset:28768
    ds_read_b128 v[116:119], v27 offset:29792
    ds_read_b128 v[120:123], v27 offset:30816
    ds_read_b128 v[124:127], v27 offset:31840
    s_mov_b32 s48, 1572864
    s_waitcnt lgkmcnt(7)
    buffer_store_dwordx4 v[96:99], v26, s[28:31], s48 offen offset:0 sc1
    s_mov_b32 s48, 1572864
    s_waitcnt lgkmcnt(6)
    buffer_store_dwordx4 v[100:103], v26, s[28:31], s48 offen offset:1024 sc1
    s_mov_b32 s48, 1703936
    s_waitcnt lgkmcnt(5)
    buffer_store_dwordx4 v[104:107], v26, s[28:31], s48 offen offset:0 sc1
    s_mov_b32 s48, 1703936
    s_waitcnt lgkmcnt(4)
    buffer_store_dwordx4 v[108:111], v26, s[28:31], s48 offen offset:1024 sc1
    s_mov_b32 s48, 1835008
    s_waitcnt lgkmcnt(3)
    buffer_store_dwordx4 v[112:115], v26, s[28:31], s48 offen offset:0 sc1
    s_mov_b32 s48, 1835008
    s_waitcnt lgkmcnt(2)
    buffer_store_dwordx4 v[116:119], v26, s[28:31], s48 offen offset:1024 sc1
    s_mov_b32 s48, 1966080
    s_waitcnt lgkmcnt(1)
    buffer_store_dwordx4 v[120:123], v26, s[28:31], s48 offen offset:0 sc1
    s_mov_b32 s48, 1966080
    s_waitcnt lgkmcnt(0)
    buffer_store_dwordx4 v[124:127], v26, s[28:31], s48 offen offset:1024 sc1
    s_barrier
    s_branch k1_kernel_end
k1_kernel_compute:
    s_add_u32 s24, s12, 0
    s_addc_u32 s25, s13, 0
    s_and_b32 s25, s25, 0xffff
    s_mov_b32 s26, 4194304
    s_mov_b32 s27, 0x00020000
    s_mov_b32 s64, 131072
    v_lshl_add_u32 v5, v3, 3, v4
    v_cvt_f32_u32 v76, v5
    v_add_f32 v77, 4.0, v76
    v_mul_f32 v5, 1023410176, v76
    v_mul_f32 v80, v5, v52
    v_mul_f32 v81, v5, v53
    v_mul_f32 v82, v5, v54
    v_mul_f32 v83, v5, v55
    v_mul_f32 v84, v5, v56
    v_mul_f32 v85, v5, v57
    v_mul_f32 v86, v5, v58
    v_mul_f32 v87, v5, v59
    v_sin_f32 v88, v80
    v_sin_f32 v89, v81
    v_sin_f32 v90, v82
    v_sin_f32 v91, v83
    v_sin_f32 v92, v84
    v_sin_f32 v93, v85
    v_sin_f32 v94, v86
    v_sin_f32 v95, v87
    v_cos_f32 v80, v80
    v_cos_f32 v81, v81
    v_cos_f32 v82, v82
    v_cos_f32 v83, v83
    v_cos_f32 v84, v84
    v_cos_f32 v85, v85
    v_cos_f32 v86, v86
    v_cos_f32 v87, v87
    s_nop 0
    v_cvt_pk_bf16_f32 v168, v88, v89
    v_cvt_pk_bf16_f32 v160, v80, v81
    v_xor_b32 v176, 0x80008000, v168
    v_cvt_pk_bf16_f32 v169, v90, v91
    v_cvt_pk_bf16_f32 v161, v82, v83
    v_xor_b32 v177, 0x80008000, v169
    v_cvt_pk_bf16_f32 v170, v92, v93
    v_cvt_pk_bf16_f32 v162, v84, v85
    v_xor_b32 v178, 0x80008000, v170
    v_cvt_pk_bf16_f32 v171, v94, v95
    v_cvt_pk_bf16_f32 v163, v86, v87
    v_xor_b32 v179, 0x80008000, v171
    v_mul_f32 v5, 1023410176, v77
    v_mul_f32 v80, v5, v52
    v_mul_f32 v81, v5, v53
    v_mul_f32 v82, v5, v54
    v_mul_f32 v83, v5, v55
    v_mul_f32 v84, v5, v56
    v_mul_f32 v85, v5, v57
    v_mul_f32 v86, v5, v58
    v_mul_f32 v87, v5, v59
    v_sin_f32 v88, v80
    v_sin_f32 v89, v81
    v_sin_f32 v90, v82
    v_sin_f32 v91, v83
    v_sin_f32 v92, v84
    v_sin_f32 v93, v85
    v_sin_f32 v94, v86
    v_sin_f32 v95, v87
    v_cos_f32 v80, v80
    v_cos_f32 v81, v81
    v_cos_f32 v82, v82
    v_cos_f32 v83, v83
    v_cos_f32 v84, v84
    v_cos_f32 v85, v85
    v_cos_f32 v86, v86
    v_cos_f32 v87, v87
    s_nop 0
    v_cvt_pk_bf16_f32 v172, v88, v89
    v_cvt_pk_bf16_f32 v164, v80, v81
    v_xor_b32 v180, 0x80008000, v172
    v_cvt_pk_bf16_f32 v173, v90, v91
    v_cvt_pk_bf16_f32 v165, v82, v83
    v_xor_b32 v181, 0x80008000, v173
    v_cvt_pk_bf16_f32 v174, v92, v93
    v_cvt_pk_bf16_f32 v166, v84, v85
    v_xor_b32 v182, 0x80008000, v174
    v_cvt_pk_bf16_f32 v175, v94, v95
    v_cvt_pk_bf16_f32 v167, v86, v87
    v_xor_b32 v183, 0x80008000, v175
    v_mul_f32 v5, 981467136, v76
    v_mul_f32 v184, v5, v52
    v_mul_f32 v185, v5, v53
    v_mul_f32 v186, v5, v54
    v_mul_f32 v187, v5, v55
    v_sin_f32 v200, v184
    v_sin_f32 v201, v185
    v_sin_f32 v202, v186
    v_sin_f32 v203, v187
    v_cos_f32 v184, v184
    v_cos_f32 v185, v185
    v_cos_f32 v186, v186
    v_cos_f32 v187, v187
    v_mul_f32 v192, v5, v56
    v_mul_f32 v193, v5, v57
    v_mul_f32 v194, v5, v58
    v_mul_f32 v195, v5, v59
    v_sin_f32 v208, v192
    v_sin_f32 v209, v193
    v_sin_f32 v210, v194
    v_sin_f32 v211, v195
    v_cos_f32 v192, v192
    v_cos_f32 v193, v193
    v_cos_f32 v194, v194
    v_cos_f32 v195, v195
    v_mul_f32 v5, 981467136, v77
    v_mul_f32 v188, v5, v52
    v_mul_f32 v189, v5, v53
    v_mul_f32 v190, v5, v54
    v_mul_f32 v191, v5, v55
    v_sin_f32 v204, v188
    v_sin_f32 v205, v189
    v_sin_f32 v206, v190
    v_sin_f32 v207, v191
    v_cos_f32 v188, v188
    v_cos_f32 v189, v189
    v_cos_f32 v190, v190
    v_cos_f32 v191, v191
    v_mul_f32 v196, v5, v56
    v_mul_f32 v197, v5, v57
    v_mul_f32 v198, v5, v58
    v_mul_f32 v199, v5, v59
    v_sin_f32 v212, v196
    v_sin_f32 v213, v197
    v_sin_f32 v214, v198
    v_sin_f32 v215, v199
    v_cos_f32 v196, v196
    v_cos_f32 v197, v197
    v_cos_f32 v198, v198
    v_cos_f32 v199, v199
    v_mul_u32_u24 v5, 43, v0
    v_lshrrev_b32 v5, 9, v5
    v_mul_u32_u24 v6, 12, v5
    v_sub_u32 v6, v0, v6
    v_mul_u32_u24 v48, 6144, v5
    v_lshrrev_b32 v5, 2, v6
    v_lshl_add_u32 v48, v5, 11, v48
    v_and_b32 v5, 3, v6
    v_lshl_add_u32 v48, v5, 7, v48
    s_lshr_b32 s48, s2, 3
    s_lshl_b32 s48, s48, 2
    s_add_u32 s48, s48, s44
    s_mul_i32 s48, s48, 49152
    s_lshr_b32 s49, s46, 2
    s_lshl_b32 s49, s49, 9
    s_add_u32 s48, s48, s49
    v_add_u32 v48, s48, v48
    s_and_b32 s58, s44, 1
    s_lshr_b32 s59, s44, 1
    s_mov_b32 s62, 1043662067
    s_mov_b32 s63, 1069066811
    v_lshl_add_u32 v5, v2, 2, v3
    v_lshlrev_b32 v216, 6, v5
    v_lshl_add_u32 v216, v4, 3, v216
    v_and_b32 v6, 1, v2
    v_lshl_add_u32 v216, v6, 5, v216
    v_xor_b32 v217, 32, v216
    s_mul_i32 s48, s44, 8224
    s_add_u32 s48, s48, 129024
    v_add_u32 v216, s48, v216
    v_add_u32 v217, s48, v217
    v_lshrrev_b32 v5, 1, v4
    v_and_b32 v6, 1, v3
    v_lshl_add_u32 v5, v6, 1, v5
    v_xor_b32 v5, v5, v2
    v_lshl_add_u32 v218, v3, 3, v4
    v_lshlrev_b32 v218, 6, v218
    v_lshl_add_u32 v218, v5, 4, v218
    v_add_u32 v218, s48, v218
    v_and_b32 v5, 7, v1
    v_xor_b32 v5, v5, v2
    v_lshlrev_b32 v5, 4, v5
    v_lshl_add_u32 v5, v1, 7, v5
    s_lshl_b32 s48, s59, 13
    v_add_u32 v8, s48, v5
    v_xor_b32 v9, 64, v8
    v_add_u32 v10, 16384, v5
    v_xor_b32 v11, 64, v10
    v_lshl_add_u32 v12, v2, 3, v3
    v_lshlrev_b32 v12, 7, v12
    v_and_b32 v5, 1, v2
    v_lshlrev_b32 v5, 2, v5
    v_and_b32 v6, 2, v3
    v_or_b32 v5, v5, v6
    v_lshrrev_b32 v6, 1, v4
    s_lshl_b32 s48, s58, 2
    v_add_u32 v6, s48, v6
    v_xor_b32 v5, v5, v6
    v_lshl_add_u32 v12, v5, 4, v12
    v_and_b32 v5, 1, v4
    v_lshl_add_u32 v12, v5, 3, v12
    v_add_u32 v12, 18432, v12
    v_xor_b32 v13, 32, v12
    v_lshlrev_b32 v20, 18, v1
    v_and_b32 v5, 1, v2
    v_lshl_add_u32 v20, v5, 5, v20
    v_lshrrev_b32 v5, 1, v2
    v_lshl_add_u32 v20, v5, 4, v20
    s_lshl_b32 s48, s46, 13
    s_lshl_b32 s49, s45, 9
    s_add_u32 s48, s48, s49
    s_lshl_b32 s49, s59, 8
    s_add_u32 s48, s48, s49
    s_lshl_b32 s49, s58, 6
    s_add_u32 s48, s48, s49
    v_add_u32 v20, s48, v20
    s_mul_i32 s48, s58, 5120
    v_lshlrev_b32 v21, 4, v0
    v_add_u32 v21, s48, v21
    v_lshlrev_b32 v22, 3, v0
    v_add_u32 v22, s48, v22
    v_lshlrev_b32 v5, 2, v2
    v_sub_u32 v5, v1, v5
    v_mov_b32 v7, 4048155338
    v_subrev_u32 v6, 0, v5
    v_cmp_gt_u32 vcc, 8, v6
    v_cmp_gt_i32 s[68:69], -8, v6
    s_nop 0
    v_cndmask_b32_e64 v32, v7, 0, vcc
    v_cndmask_b32_e64 v36, v7, 0, s[68:69]
    v_mov_b32 v44, v36
    v_mov_b32 v40, v36
    v_subrev_u32 v6, 1, v5
    v_cmp_gt_u32 vcc, 8, v6
    v_cmp_gt_i32 s[68:69], -8, v6
    s_nop 0
    v_cndmask_b32_e64 v33, v7, 0, vcc
    v_cndmask_b32_e64 v37, v7, 0, s[68:69]
    v_mov_b32 v45, v37
    v_mov_b32 v41, v37
    v_subrev_u32 v6, 2, v5
    v_cmp_gt_u32 vcc, 8, v6
    v_cmp_gt_i32 s[68:69], -8, v6
    s_nop 0
    v_cndmask_b32_e64 v34, v7, 0, vcc
    v_cndmask_b32_e64 v38, v7, 0, s[68:69]
    v_mov_b32 v46, v38
    v_mov_b32 v42, v38
    v_subrev_u32 v6, 3, v5
    v_cmp_gt_u32 vcc, 8, v6
    v_cmp_gt_i32 s[68:69], -8, v6
    s_nop 0
    v_cndmask_b32_e64 v35, v7, 0, vcc
    v_cndmask_b32_e64 v39, v7, 0, s[68:69]
    v_mov_b32 v47, v39
    v_mov_b32 v43, v39
    s_cmp_lg_u32 s59, 0
    s_cbranch_scc1 k1_kernel_maskdone
    v_cmp_gt_u32 s[68:69], 2, v2
    v_subrev_u32 v6, 0, v5
    v_cmp_gt_i32 vcc, 0, v6
    s_nop 1
    s_and_b64 vcc, vcc, s[68:69]
    s_nop 1
    v_cndmask_b32_e64 v40, v7, 0, vcc
    v_subrev_u32 v6, 1, v5
    v_cmp_gt_i32 vcc, 0, v6
    s_nop 1
    s_and_b64 vcc, vcc, s[68:69]
    s_nop 1
    v_cndmask_b32_e64 v41, v7, 0, vcc
    v_subrev_u32 v6, 2, v5
    v_cmp_gt_i32 vcc, 0, v6
    s_nop 1
    s_and_b64 vcc, vcc, s[68:69]
    s_nop 1
    v_cndmask_b32_e64 v42, v7, 0, vcc
    v_subrev_u32 v6, 3, v5
    v_cmp_gt_i32 vcc, 0, v6
    s_nop 1
    s_and_b64 vcc, vcc, s[68:69]
    s_nop 1
    v_cndmask_b32_e64 v43, v7, 0, vcc
    s_cmp_lg_u32 s45, 0
    s_cbranch_scc1 k1_kernel_maskdone
    v_mov_b32 v40, v7
    v_mov_b32 v44, v7
    v_mov_b32 v41, v7
    v_mov_b32 v45, v7
    v_mov_b32 v42, v7
    v_mov_b32 v46, v7
    v_mov_b32 v43, v7
    v_mov_b32 v47, v7
k1_kernel_maskdone:
    v_ashrrev_i32 v5, 31, v32
    v_ashrrev_i32 v6, 31, v33
    v_and_b32 v5, 0xffff, v5
    v_and_b32 v6, 0xffff0000, v6
    v_or_b32 v5, v5, v6
    v_not_b32 v24, v5
    v_ashrrev_i32 v5, 31, v34
    v_ashrrev_i32 v6, 31, v35
    v_and_b32 v5, 0xffff, v5
    v_and_b32 v6, 0xffff0000, v6
    v_or_b32 v5, v5, v6
    v_not_b32 v25, v5
    v_ashrrev_i32 v5, 31, v36
    v_ashrrev_i32 v6, 31, v37
    v_and_b32 v5, 0xffff, v5
    v_and_b32 v6, 0xffff0000, v6
    v_or_b32 v5, v5, v6
    v_not_b32 v26, v5
    v_ashrrev_i32 v5, 31, v38
    v_ashrrev_i32 v6, 31, v39
    v_and_b32 v5, 0xffff, v5
    v_and_b32 v6, 0xffff0000, v6
    v_or_b32 v5, v5, v6
    v_not_b32 v27, v5
    v_ashrrev_i32 v5, 31, v40
    v_ashrrev_i32 v6, 31, v41
    v_and_b32 v5, 0xffff, v5
    v_and_b32 v6, 0xffff0000, v6
    v_or_b32 v5, v5, v6
    v_not_b32 v28, v5
    v_ashrrev_i32 v5, 31, v42
    v_ashrrev_i32 v6, 31, v43
    v_and_b32 v5, 0xffff, v5
    v_and_b32 v6, 0xffff0000, v6
    v_or_b32 v5, v5, v6
    v_not_b32 v29, v5
    v_ashrrev_i32 v5, 31, v44
    v_ashrrev_i32 v6, 31, v45
    v_and_b32 v5, 0xffff, v5
    v_and_b32 v6, 0xffff0000, v6
    v_or_b32 v5, v5, v6
    v_not_b32 v30, v5
    v_ashrrev_i32 v5, 31, v46
    v_ashrrev_i32 v6, 31, v47
    v_and_b32 v5, 0xffff, v5
    v_and_b32 v6, 0xffff0000, v6
    v_or_b32 v5, v5, v6
    v_not_b32 v31, v5
    s_waitcnt vmcnt(0)
    s_barrier
    s_mov_b32 s48, 24576
    s_mov_b32 exec_hi, 0xffff
    buffer_load_dword v49, v48, s[20:23], 0 offen
    buffer_load_dword v50, v48, s[20:23], s48 offen
    s_mov_b32 exec_hi, -1
    ds_read_b64_tr_b16 v[96:97], v64 offset:0
    ds_read_b64_tr_b16 v[98:99], v64 offset:32768
    ds_read_b64_tr_b16 v[100:101], v68 offset:0
    ds_read_b64_tr_b16 v[102:103], v68 offset:32768
    ds_read_b64_tr_b16 v[104:105], v69 offset:0
    ds_read_b64_tr_b16 v[106:107], v69 offset:32768
    ds_read_b64_tr_b16 v[108:109], v70 offset:0
    ds_read_b64_tr_b16 v[110:111], v70 offset:32768
    ds_read_b64_tr_b16 v[112:113], v71 offset:0
    ds_read_b64_tr_b16 v[114:115], v71 offset:32768
    ds_read_b64_tr_b16 v[116:117], v72 offset:0
    ds_read_b64_tr_b16 v[118:119], v72 offset:32768
    ds_read_b64_tr_b16 v[120:121], v73 offset:0
    ds_read_b64_tr_b16 v[122:123], v73 offset:32768
    ds_read_b64_tr_b16 v[124:125], v74 offset:0
    ds_read_b64_tr_b16 v[126:127], v74 offset:32768
    s_waitcnt lgkmcnt(14)
    v_mfma_f32_16x16x32_bf16 v[128:131], v[96:99], v[60:63], 0
    s_waitcnt lgkmcnt(12)
    v_mfma_f32_16x16x32_bf16 v[132:135], v[100:103], v[60:63], 0
    s_waitcnt lgkmcnt(10)
    v_mfma_f32_16x16x32_bf16 v[136:139], v[104:107], v[60:63], 0
    s_waitcnt lgkmcnt(8)
    v_mfma_f32_16x16x32_bf16 v[140:143], v[108:111], v[60:63], 0
    s_waitcnt lgkmcnt(6)
    v_mfma_f32_16x16x32_bf16 v[144:147], v[112:115], v[60:63], 0
    s_waitcnt lgkmcnt(4)
    v_mfma_f32_16x16x32_bf16 v[148:151], v[116:119], v[60:63], 0
    s_waitcnt lgkmcnt(2)
    v_mfma_f32_16x16x32_bf16 v[152:155], v[120:123], v[60:63], 0
    s_waitcnt lgkmcnt(0)
    v_mfma_f32_16x16x32_bf16 v[156:159], v[124:127], v[60:63], 0
    s_nop 3
    v_cvt_pk_bf16_f32 v128, v128, v129
    v_cvt_pk_bf16_f32 v129, v130, v131
    ds_write_b64 v65, v[128:129] offset:0
    v_cvt_pk_bf16_f32 v132, v132, v133
    v_cvt_pk_bf16_f32 v133, v134, v135
    ds_write_b64 v66, v[132:133] offset:0
    v_cvt_pk_bf16_f32 v136, v136, v137
    v_cvt_pk_bf16_f32 v137, v138, v139
    ds_write_b64 v65, v[136:137] offset:64
    v_cvt_pk_bf16_f32 v140, v140, v141
    v_cvt_pk_bf16_f32 v141, v142, v143
    ds_write_b64 v66, v[140:141] offset:64
    v_cvt_pk_bf16_f32 v144, v144, v145
    v_cvt_pk_bf16_f32 v145, v146, v147
    ds_write_b64 v65, v[144:145] offset:128
    v_cvt_pk_bf16_f32 v148, v148, v149
    v_cvt_pk_bf16_f32 v149, v150, v151
    ds_write_b64 v66, v[148:149] offset:128
    v_cvt_pk_bf16_f32 v152, v152, v153
    v_cvt_pk_bf16_f32 v153, v154, v155
    ds_write_b64 v65, v[152:153] offset:192
    v_cvt_pk_bf16_f32 v156, v156, v157
    v_cvt_pk_bf16_f32 v157, v158, v159
    ds_write_b64 v66, v[156:157] offset:192
    s_waitcnt lgkmcnt(0)
    s_barrier
    ds_read_b64_tr_b16 v[96:97], v216 offset:0
    ds_read_b64_tr_b16 v[98:99], v216 offset:1024
    ds_read_b64_tr_b16 v[100:101], v217 offset:0
    ds_read_b64_tr_b16 v[102:103], v217 offset:1024
    ds_read_b64_tr_b16 v[104:105], v216 offset:2056
    ds_read_b64_tr_b16 v[106:107], v216 offset:3080
    ds_read_b64_tr_b16 v[108:109], v217 offset:2056
    ds_read_b64_tr_b16 v[110:111], v217 offset:3080
    ds_read_b64_tr_b16 v[112:113], v216 offset:4112
    ds_read_b64_tr_b16 v[114:115], v216 offset:5136
    ds_read_b64_tr_b16 v[116:117], v217 offset:4112
    ds_read_b64_tr_b16 v[118:119], v217 offset:5136
    ds_read_b64_tr_b16 v[120:121], v216 offset:6168
    ds_read_b64_tr_b16 v[122:123], v216 offset:7192
    ds_read_b64_tr_b16 v[124:125], v217 offset:6168
    ds_read_b64_tr_b16 v[126:127], v217 offset:7192
    s_waitcnt lgkmcnt(12)
    v_mfma_f32_16x16x32_bf16 v[128:131], v[96:99], v[160:163], 0
    v_mfma_f32_16x16x32_bf16 v[144:147], v[96:99], v[176:179], 0
    v_mfma_f32_16x16x32_bf16 v[132:135], v[96:99], v[164:167], 0
    v_mfma_f32_16x16x32_bf16 v[148:151], v[96:99], v[180:183], 0
    v_mfma_f32_16x16x32_bf16 v[136:139], v[100:103], v[160:163], 0
    v_mfma_f32_16x16x32_bf16 v[152:155], v[100:103], v[176:179], 0
    v_mfma_f32_16x16x32_bf16 v[140:143], v[100:103], v[164:167], 0
    v_mfma_f32_16x16x32_bf16 v[156:159], v[100:103], v[180:183], 0
    s_waitcnt lgkmcnt(8)
    v_mfma_f32_16x16x32_bf16 v[128:131], v[104:107], v[168:171], v[128:131]
    v_mfma_f32_16x16x32_bf16 v[144:147], v[104:107], v[160:163], v[144:147]
    v_mfma_f32_16x16x32_bf16 v[132:135], v[104:107], v[172:175], v[132:135]
    v_mfma_f32_16x16x32_bf16 v[148:151], v[104:107], v[164:167], v[148:151]
    v_mfma_f32_16x16x32_bf16 v[136:139], v[108:111], v[168:171], v[136:139]
    v_mfma_f32_16x16x32_bf16 v[152:155], v[108:111], v[160:163], v[152:155]
    v_mfma_f32_16x16x32_bf16 v[140:143], v[108:111], v[172:175], v[140:143]
    v_mfma_f32_16x16x32_bf16 v[156:159], v[108:111], v[164:167], v[156:159]
    s_waitcnt lgkmcnt(0)
    v_mfma_f32_16x16x32_bf16 v[52:55], v[112:115], v[160:163], 0
    v_mfma_f32_16x16x32_bf16 v[68:71], v[112:115], v[176:179], 0
    v_mfma_f32_16x16x32_bf16 v[56:59], v[112:115], v[164:167], 0
    v_mul_f32 v88, v128, v184
    v_mul_f32 v92, v128, v200
    v_mul_f32 v89, v129, v185
    v_mul_f32 v93, v129, v201
    v_mul_f32 v90, v130, v186
    v_mul_f32 v94, v130, v202
    v_mfma_f32_16x16x32_bf16 v[72:75], v[112:115], v[180:183], 0
    v_mul_f32 v91, v131, v187
    v_mul_f32 v95, v131, v203
    v_fma_f32 v88, v144, v200, v88
    v_fma_f32 v92, -v144, v184, v92
    v_fma_f32 v89, v145, v201, v89
    v_fma_f32 v93, -v145, v185, v93
    v_mfma_f32_16x16x32_bf16 v[60:63], v[116:119], v[160:163], 0
    v_fma_f32 v90, v146, v202, v90
    v_fma_f32 v94, -v146, v186, v94
    v_fma_f32 v91, v147, v203, v91
    v_fma_f32 v95, -v147, v187, v95
    v_cvt_pk_bf16_f32 v220, v88, v89
    v_cvt_pk_bf16_f32 v228, v92, v93
    v_mfma_f32_16x16x32_bf16 v[76:79], v[116:119], v[176:179], 0
    v_cvt_pk_bf16_f32 v221, v90, v91
    v_cvt_pk_bf16_f32 v229, v94, v95
    v_mul_f32 v88, v132, v188
    v_mul_f32 v92, v132, v204
    v_mul_f32 v89, v133, v189
    v_mul_f32 v93, v133, v205
    v_mfma_f32_16x16x32_bf16 v[64:67], v[116:119], v[164:167], 0
    v_mul_f32 v90, v134, v190
    v_mul_f32 v94, v134, v206
    v_mul_f32 v91, v135, v191
    v_mul_f32 v95, v135, v207
    v_fma_f32 v88, v148, v204, v88
    v_fma_f32 v92, -v148, v188, v92
    v_mfma_f32_16x16x32_bf16 v[80:83], v[116:119], v[180:183], 0
    v_fma_f32 v89, v149, v205, v89
    v_fma_f32 v93, -v149, v189, v93
    v_fma_f32 v90, v150, v206, v90
    v_fma_f32 v94, -v150, v190, v94
    v_fma_f32 v91, v151, v207, v91
    v_fma_f32 v95, -v151, v191, v95
    v_mfma_f32_16x16x32_bf16 v[52:55], v[120:123], v[168:171], v[52:55]
    v_cvt_pk_bf16_f32 v224, v88, v89
    v_cvt_pk_bf16_f32 v232, v92, v93
    v_cvt_pk_bf16_f32 v225, v90, v91
    v_cvt_pk_bf16_f32 v233, v94, v95
    v_mul_f32 v88, v136, v192
    v_mul_f32 v92, v136, v208
    v_mfma_f32_16x16x32_bf16 v[68:71], v[120:123], v[160:163], v[68:71]
    v_mul_f32 v89, v137, v193
    v_mul_f32 v93, v137, v209
    v_mul_f32 v90, v138, v194
    v_mul_f32 v94, v138, v210
    v_mul_f32 v91, v139, v195
    v_mul_f32 v95, v139, v211
    v_mfma_f32_16x16x32_bf16 v[56:59], v[120:123], v[172:175], v[56:59]
    v_fma_f32 v88, v152, v208, v88
    v_fma_f32 v92, -v152, v192, v92
    v_fma_f32 v89, v153, v209, v89
    v_fma_f32 v93, -v153, v193, v93
    v_fma_f32 v90, v154, v210, v90
    v_fma_f32 v94, -v154, v194, v94
    v_mfma_f32_16x16x32_bf16 v[72:75], v[120:123], v[164:167], v[72:75]
    v_fma_f32 v91, v155, v211, v91
    v_fma_f32 v95, -v155, v195, v95
    v_cvt_pk_bf16_f32 v222, v88, v89
    v_cvt_pk_bf16_f32 v230, v92, v93
    v_cvt_pk_bf16_f32 v223, v90, v91
    v_cvt_pk_bf16_f32 v231, v94, v95
    v_mfma_f32_16x16x32_bf16 v[60:63], v[124:127], v[168:171], v[60:63]
    v_mul_f32 v88, v140, v196
    v_mul_f32 v92, v140, v212
    v_mul_f32 v89, v141, v197
    v_mul_f32 v93, v141, v213
    v_mul_f32 v90, v142, v198
    v_mul_f32 v94, v142, v214
    v_mfma_f32_16x16x32_bf16 v[76:79], v[124:127], v[160:163], v[76:79]
    v_mul_f32 v91, v143, v199
    v_mul_f32 v95, v143, v215
    v_fma_f32 v88, v156, v212, v88
    v_fma_f32 v92, -v156, v196, v92
    v_fma_f32 v89, v157, v213, v89
    v_fma_f32 v93, -v157, v197, v93
    v_mfma_f32_16x16x32_bf16 v[64:67], v[124:127], v[172:175], v[64:67]
    v_fma_f32 v90, v158, v214, v90
    v_fma_f32 v94, -v158, v198, v94
    v_fma_f32 v91, v159, v215, v91
    v_fma_f32 v95, -v159, v199, v95
    v_cvt_pk_bf16_f32 v226, v88, v89
    v_cvt_pk_bf16_f32 v234, v92, v93
    v_mfma_f32_16x16x32_bf16 v[80:83], v[124:127], v[164:167], v[80:83]
    v_cvt_pk_bf16_f32 v227, v90, v91
    v_cvt_pk_bf16_f32 v235, v94, v95
    s_nop 1
    v_mfma_f32_16x16x32_bf16 v[128:131], v[220:223], v[160:163], 0
    v_mfma_f32_16x16x32_bf16 v[144:147], v[220:223], v[168:171], 0
    v_mfma_f32_16x16x32_bf16 v[136:139], v[224:227], v[160:163], 0
    v_mul_f32 v88, v52, v184
    v_mul_f32 v92, v52, v200
    v_mul_f32 v89, v53, v185
    v_mul_f32 v93, v53, v201
    v_mul_f32 v90, v54, v186
    v_mul_f32 v94, v54, v202
    v_mfma_f32_16x16x32_bf16 v[152:155], v[224:227], v[168:171], 0
    v_mul_f32 v91, v55, v187
    v_mul_f32 v95, v55, v203
    v_fma_f32 v88, v68, v200, v88
    v_fma_f32 v92, -v68, v184, v92
    v_fma_f32 v89, v69, v201, v89
    v_fma_f32 v93, -v69, v185, v93
    v_mfma_f32_16x16x32_bf16 v[132:135], v[220:223], v[164:167], 0
    v_fma_f32 v90, v70, v202, v90
    v_fma_f32 v94, -v70, v186, v94
    v_fma_f32 v91, v71, v203, v91
    v_fma_f32 v95, -v71, v187, v95
    v_cvt_pk_bf16_f32 v96, v88, v89
    v_cvt_pk_bf16_f32 v104, v92, v93
    v_mfma_f32_16x16x32_bf16 v[148:151], v[220:223], v[172:175], 0
    v_cvt_pk_bf16_f32 v97, v90, v91
    v_cvt_pk_bf16_f32 v105, v94, v95
    v_mul_f32 v88, v56, v188
    v_mul_f32 v92, v56, v204
    v_mul_f32 v89, v57, v189
    v_mul_f32 v93, v57, v205
    v_mfma_f32_16x16x32_bf16 v[140:143], v[224:227], v[164:167], 0
    v_mul_f32 v90, v58, v190
    v_mul_f32 v94, v58, v206
    v_mul_f32 v91, v59, v191
    v_mul_f32 v95, v59, v207
    v_fma_f32 v88, v72, v204, v88
    v_fma_f32 v92, -v72, v188, v92
    v_mfma_f32_16x16x32_bf16 v[156:159], v[224:227], v[172:175], 0
    v_fma_f32 v89, v73, v205, v89
    v_fma_f32 v93, -v73, v189, v93
    v_fma_f32 v90, v74, v206, v90
    v_fma_f32 v94, -v74, v190, v94
    v_fma_f32 v91, v75, v207, v91
    v_fma_f32 v95, -v75, v191, v95
    v_mfma_f32_16x16x32_bf16 v[128:131], v[228:231], v[176:179], v[128:131]
    v_cvt_pk_bf16_f32 v100, v88, v89
    v_cvt_pk_bf16_f32 v108, v92, v93
    v_cvt_pk_bf16_f32 v101, v90, v91
    v_cvt_pk_bf16_f32 v109, v94, v95
    v_mul_f32 v88, v60, v192
    v_mul_f32 v92, v60, v208
    v_mfma_f32_16x16x32_bf16 v[144:147], v[228:231], v[160:163], v[144:147]
    v_mul_f32 v89, v61, v193
    v_mul_f32 v93, v61, v209
    v_mul_f32 v90, v62, v194
    v_mul_f32 v94, v62, v210
    v_mul_f32 v91, v63, v195
    v_mul_f32 v95, v63, v211
    v_mfma_f32_16x16x32_bf16 v[136:139], v[232:235], v[176:179], v[136:139]
    v_fma_f32 v88, v76, v208, v88
    v_fma_f32 v92, -v76, v192, v92
    v_fma_f32 v89, v77, v209, v89
    v_fma_f32 v93, -v77, v193, v93
    v_fma_f32 v90, v78, v210, v90
    v_fma_f32 v94, -v78, v194, v94
    v_mfma_f32_16x16x32_bf16 v[152:155], v[232:235], v[160:163], v[152:155]
    v_fma_f32 v91, v79, v211, v91
    v_fma_f32 v95, -v79, v195, v95
    v_cvt_pk_bf16_f32 v98, v88, v89
    v_cvt_pk_bf16_f32 v106, v92, v93
    v_cvt_pk_bf16_f32 v99, v90, v91
    v_cvt_pk_bf16_f32 v107, v94, v95
    v_mfma_f32_16x16x32_bf16 v[132:135], v[228:231], v[180:183], v[132:135]
    v_mul_f32 v88, v64, v196
    v_mul_f32 v92, v64, v212
    v_mul_f32 v89, v65, v197
    v_mul_f32 v93, v65, v213
    v_mul_f32 v90, v66, v198
    v_mul_f32 v94, v66, v214
    v_mfma_f32_16x16x32_bf16 v[148:151], v[228:231], v[164:167], v[148:151]
    v_mul_f32 v91, v67, v199
    v_mul_f32 v95, v67, v215
    v_fma_f32 v88, v80, v212, v88
    v_fma_f32 v92, -v80, v196, v92
    v_fma_f32 v89, v81, v213, v89
    v_fma_f32 v93, -v81, v197, v93
    v_mfma_f32_16x16x32_bf16 v[140:143], v[232:235], v[180:183], v[140:143]
    v_fma_f32 v90, v82, v214, v90
    v_fma_f32 v94, -v82, v198, v94
    v_fma_f32 v91, v83, v215, v91
    v_fma_f32 v95, -v83, v199, v95
    v_cvt_pk_bf16_f32 v102, v88, v89
    v_cvt_pk_bf16_f32 v110, v92, v93
    v_mfma_f32_16x16x32_bf16 v[156:159], v[232:235], v[164:167], v[156:159]
    v_cvt_pk_bf16_f32 v103, v90, v91
    v_cvt_pk_bf16_f32 v111, v94, v95
    s_nop 1
    v_mfma_f32_16x16x32_bf16 v[52:55], v[96:99], v[160:163], 0
    v_mfma_f32_16x16x32_bf16 v[68:71], v[96:99], v[168:171], 0
    v_mfma_f32_16x16x32_bf16 v[60:63], v[100:103], v[160:163], 0
    v_mfma_f32_16x16x32_bf16 v[76:79], v[100:103], v[168:171], 0
    v_mfma_f32_16x16x32_bf16 v[56:59], v[96:99], v[164:167], 0
    v_cvt_pk_bf16_f32 v112, v128, v129
    v_cvt_pk_bf16_f32 v113, v130, v131
    v_mfma_f32_16x16x32_bf16 v[72:75], v[96:99], v[172:175], 0
    v_cvt_pk_bf16_f32 v114, v136, v137
    v_cvt_pk_bf16_f32 v115, v138, v139
    v_mfma_f32_16x16x32_bf16 v[64:67], v[100:103], v[164:167], 0
    ds_write_b128 v218, v[112:115] offset:0
    v_cvt_pk_bf16_f32 v116, v144, v145
    v_mfma_f32_16x16x32_bf16 v[80:83], v[100:103], v[172:175], 0
    v_cvt_pk_bf16_f32 v117, v146, v147
    v_cvt_pk_bf16_f32 v118, v152, v153
    v_mfma_f32_16x16x32_bf16 v[52:55], v[104:107], v[176:179], v[52:55]
    v_cvt_pk_bf16_f32 v119, v154, v155
    ds_write_b128 v218, v[116:119] offset:2048
    v_mfma_f32_16x16x32_bf16 v[68:71], v[104:107], v[160:163], v[68:71]
    v_cvt_pk_bf16_f32 v120, v132, v133
    v_cvt_pk_bf16_f32 v121, v134, v135
    v_mfma_f32_16x16x32_bf16 v[60:63], v[108:111], v[176:179], v[60:63]
    v_cvt_pk_bf16_f32 v122, v140, v141
    v_cvt_pk_bf16_f32 v123, v142, v143
    v_mfma_f32_16x16x32_bf16 v[76:79], v[108:111], v[160:163], v[76:79]
    ds_write_b128 v218, v[120:123] offset:256
    v_cvt_pk_bf16_f32 v124, v148, v149
    v_mfma_f32_16x16x32_bf16 v[56:59], v[104:107], v[180:183], v[56:59]
    v_cvt_pk_bf16_f32 v125, v150, v151
    v_cvt_pk_bf16_f32 v126, v156, v157
    v_mfma_f32_16x16x32_bf16 v[72:75], v[104:107], v[164:167], v[72:75]
    v_cvt_pk_bf16_f32 v127, v158, v159
    ds_write_b128 v218, v[124:127] offset:2304
    v_mfma_f32_16x16x32_bf16 v[64:67], v[108:111], v[180:183], v[64:67]
    v_mfma_f32_16x16x32_bf16 v[80:83], v[108:111], v[164:167], v[80:83]
    s_nop 3
    v_cvt_pk_bf16_f32 v220, v52, v53
    v_cvt_pk_bf16_f32 v221, v54, v55
    v_cvt_pk_bf16_f32 v222, v60, v61
    v_cvt_pk_bf16_f32 v223, v62, v63
    ds_write_b128 v218, v[220:223] offset:4096
    v_cvt_pk_bf16_f32 v224, v68, v69
    v_cvt_pk_bf16_f32 v225, v70, v71
    v_cvt_pk_bf16_f32 v226, v76, v77
    v_cvt_pk_bf16_f32 v227, v78, v79
    ds_write_b128 v218, v[224:227] offset:6144
    v_cvt_pk_bf16_f32 v228, v56, v57
    v_cvt_pk_bf16_f32 v229, v58, v59
    v_cvt_pk_bf16_f32 v230, v64, v65
    v_cvt_pk_bf16_f32 v231, v66, v67
    ds_write_b128 v218, v[228:231] offset:4352
    v_cvt_pk_bf16_f32 v232, v72, v73
    v_cvt_pk_bf16_f32 v233, v74, v75
    v_cvt_pk_bf16_f32 v234, v80, v81
    v_cvt_pk_bf16_f32 v235, v82, v83
    ds_write_b128 v218, v[232:235] offset:6400
    s_waitcnt lgkmcnt(0)
    s_barrier
    ds_read_b128 v[200:203], v8 offset:0
    ds_read_b64_tr_b16 v[220:221], v12 offset:0
    ds_read_b64_tr_b16 v[222:223], v12 offset:512
    ds_read_b64_tr_b16 v[224:225], v13 offset:0
    ds_read_b64_tr_b16 v[226:227], v13 offset:512
    ds_read_b128 v[204:207], v8 offset:2048
    ds_read_b128 v[208:211], v8 offset:4096
    ds_read_b128 v[212:215], v8 offset:6144
    ds_read_b64_tr_b16 v[228:229], v12 offset:8192
    ds_read_b64_tr_b16 v[230:231], v12 offset:8704
    ds_read_b64_tr_b16 v[232:233], v13 offset:8192
    ds_read_b64_tr_b16 v[234:235], v13 offset:8704
    ds_read_b128 v[216:219], v10
    ds_read_b64_tr_b16 v[236:237], v12 offset:16384
    ds_read_b64_tr_b16 v[238:239], v12 offset:16896
    ds_read_b64_tr_b16 v[240:241], v13 offset:16384
    ds_read_b64_tr_b16 v[242:243], v13 offset:16896
    v_mov_b32 v15, v9
    v_mov_b32 v17, v11
    v_mov_b32 v18, v12
    v_mov_b32 v19, v13
    s_mov_b32 s56, 0
    s_mov_b32 s55, 0
    s_waitcnt lgkmcnt(0)
    s_cmp_eq_u32 s59, 0
    s_cbranch_scc0 k1_kernel_first1
k1_kernel_first0:
    v_mfma_f32_16x16x32_bf16 v[52:55], v[220:223], v[200:203], 0
    ds_read_b128 v[156:159], v15 offset:0
    v_mfma_f32_16x16x32_bf16 v[56:59], v[224:227], v[200:203], 0
    ds_read_b64_tr_b16 v[176:177], v18 offset:4096
    v_mfma_f32_16x16x32_bf16 v[60:63], v[220:223], v[204:207], 0
    ds_read_b64_tr_b16 v[178:179], v18 offset:4608
    v_mfma_f32_16x16x32_bf16 v[64:67], v[224:227], v[204:207], 0
    ds_read_b64_tr_b16 v[180:181], v19 offset:4096
    v_mfma_f32_16x16x32_bf16 v[68:71], v[220:223], v[208:211], 0
    ds_read_b64_tr_b16 v[182:183], v19 offset:4608
    v_mfma_f32_16x16x32_bf16 v[72:75], v[224:227], v[208:211], 0
    ds_read_b128 v[160:163], v15 offset:2048
    v_mfma_f32_16x16x32_bf16 v[76:79], v[220:223], v[212:215], 0
    ds_read_b128 v[164:167], v15 offset:4096
    v_mfma_f32_16x16x32_bf16 v[80:83], v[224:227], v[212:215], 0
    ds_read_b128 v[168:171], v15 offset:6144
    v_mfma_f32_16x16x32_bf16 v[84:87], v[228:231], v[200:203], 0
    ds_read_b64_tr_b16 v[184:185], v18 offset:12288
    v_mfma_f32_16x16x32_bf16 v[88:91], v[232:235], v[200:203], 0
    ds_read_b64_tr_b16 v[186:187], v18 offset:12800
    v_mfma_f32_16x16x32_bf16 v[92:95], v[228:231], v[204:207], 0
    ds_read_b64_tr_b16 v[188:189], v19 offset:12288
    v_mfma_f32_16x16x32_bf16 v[96:99], v[232:235], v[204:207], 0
    ds_read_b64_tr_b16 v[190:191], v19 offset:12800
    v_mfma_f32_16x16x32_bf16 v[100:103], v[228:231], v[208:211], 0
    ds_read_b128 v[172:175], v17
    v_mfma_f32_16x16x32_bf16 v[104:107], v[232:235], v[208:211], 0
    ds_read_b64_tr_b16 v[192:193], v18 offset:20480
    v_mfma_f32_16x16x32_bf16 v[108:111], v[228:231], v[212:215], 0
    ds_read_b64_tr_b16 v[194:195], v18 offset:20992
    v_mfma_f32_16x16x32_bf16 v[112:115], v[232:235], v[212:215], 0
    ds_read_b64_tr_b16 v[196:197], v19 offset:20480
    v_mfma_f32_16x16x32_bf16 v[148:151], v[228:231], v[216:219], 0
    ds_read_b64_tr_b16 v[198:199], v19 offset:20992
    v_mfma_f32_16x16x32_bf16 v[152:155], v[232:235], v[216:219], 0
    s_add_u32 s56, s56, 43008
    v_mfma_f32_16x16x32_bf16 v[116:119], v[200:203], v[236:239], 0
    s_cmp_eq_u32 s56, 129024
    v_mfma_f32_16x16x32_bf16 v[120:123], v[200:203], v[240:243], 0
    s_cselect_b32 s56, 0, s56
    v_mfma_f32_16x16x32_bf16 v[124:127], v[204:207], v[236:239], 0
    v_add_u32 v14, s56, v8
    v_mfma_f32_16x16x32_bf16 v[128:131], v[204:207], v[240:243], 0
    v_add_u32 v16, s56, v10
    v_mfma_f32_16x16x32_bf16 v[132:135], v[208:211], v[236:239], 0
    v_add_u32 v18, s56, v12
    v_mfma_f32_16x16x32_bf16 v[136:139], v[208:211], v[240:243], 0
    v_add_u32 v19, s56, v13
    v_mfma_f32_16x16x32_bf16 v[140:143], v[212:215], v[236:239], 0
    v_add_u32 v15, s56, v9
    v_mfma_f32_16x16x32_bf16 v[144:147], v[212:215], v[240:243], 0
    v_add_u32 v17, s56, v11
k1_kernel_loop0:
    s_waitcnt lgkmcnt(0)
    s_barrier
    v_mfma_f32_16x16x32_bf16 v[52:55], v[176:179], v[156:159], v[52:55]
    ds_read_b128 v[200:203], v14 offset:0
    v_mfma_f32_16x16x32_bf16 v[56:59], v[180:183], v[156:159], v[56:59]
    ds_read_b64_tr_b16 v[220:221], v18 offset:0
    v_mfma_f32_16x16x32_bf16 v[60:63], v[176:179], v[160:163], v[60:63]
    ds_read_b64_tr_b16 v[222:223], v18 offset:512
    v_mfma_f32_16x16x32_bf16 v[64:67], v[180:183], v[160:163], v[64:67]
    ds_read_b64_tr_b16 v[224:225], v19 offset:0
    v_mfma_f32_16x16x32_bf16 v[68:71], v[176:179], v[164:167], v[68:71]
    ds_read_b64_tr_b16 v[226:227], v19 offset:512
    v_mfma_f32_16x16x32_bf16 v[72:75], v[180:183], v[164:167], v[72:75]
    ds_read_b128 v[204:207], v14 offset:2048
    v_mfma_f32_16x16x32_bf16 v[76:79], v[176:179], v[168:171], v[76:79]
    ds_read_b128 v[208:211], v14 offset:4096
    v_mfma_f32_16x16x32_bf16 v[80:83], v[180:183], v[168:171], v[80:83]
    ds_read_b128 v[212:215], v14 offset:6144
    v_mfma_f32_16x16x32_bf16 v[84:87], v[184:187], v[156:159], v[84:87]
    ds_read_b64_tr_b16 v[228:229], v18 offset:8192
    v_mfma_f32_16x16x32_bf16 v[88:91], v[188:191], v[156:159], v[88:91]
    ds_read_b64_tr_b16 v[230:231], v18 offset:8704
    v_mfma_f32_16x16x32_bf16 v[92:95], v[184:187], v[160:163], v[92:95]
    ds_read_b64_tr_b16 v[232:233], v19 offset:8192
    v_mfma_f32_16x16x32_bf16 v[96:99], v[188:191], v[160:163], v[96:99]
    ds_read_b64_tr_b16 v[234:235], v19 offset:8704
    v_mfma_f32_16x16x32_bf16 v[100:103], v[184:187], v[164:167], v[100:103]
    ds_read_b128 v[216:219], v16
    v_mfma_f32_16x16x32_bf16 v[104:107], v[188:191], v[164:167], v[104:107]
    ds_read_b64_tr_b16 v[236:237], v18 offset:16384
    v_mfma_f32_16x16x32_bf16 v[108:111], v[184:187], v[168:171], v[108:111]
    ds_read_b64_tr_b16 v[238:239], v18 offset:16896
    v_mfma_f32_16x16x32_bf16 v[112:115], v[188:191], v[168:171], v[112:115]
    ds_read_b64_tr_b16 v[240:241], v19 offset:16384
    v_mfma_f32_16x16x32_bf16 v[148:151], v[184:187], v[172:175], v[148:151]
    ds_read_b64_tr_b16 v[242:243], v19 offset:16896
    v_mfma_f32_16x16x32_bf16 v[152:155], v[188:191], v[172:175], v[152:155]
    s_add_u32 s55, s55, 1
    v_mfma_f32_16x16x32_bf16 v[116:119], v[156:159], v[192:195], v[116:119]
    v_mfma_f32_16x16x32_bf16 v[120:123], v[156:159], v[196:199], v[120:123]
    v_mfma_f32_16x16x32_bf16 v[124:127], v[160:163], v[192:195], v[124:127]
    v_mfma_f32_16x16x32_bf16 v[128:131], v[160:163], v[196:199], v[128:131]
    v_mfma_f32_16x16x32_bf16 v[132:135], v[164:167], v[192:195], v[132:135]
    v_mfma_f32_16x16x32_bf16 v[136:139], v[164:167], v[196:199], v[136:139]
    v_mfma_f32_16x16x32_bf16 v[140:143], v[168:171], v[192:195], v[140:143]
    v_mfma_f32_16x16x32_bf16 v[144:147], v[168:171], v[196:199], v[144:147]
    s_waitcnt lgkmcnt(0)
    v_mfma_f32_16x16x32_bf16 v[52:55], v[220:223], v[200:203], v[52:55]
    ds_read_b128 v[156:159], v15 offset:0
    v_mfma_f32_16x16x32_bf16 v[56:59], v[224:227], v[200:203], v[56:59]
    ds_read_b64_tr_b16 v[176:177], v18 offset:4096
    v_mfma_f32_16x16x32_bf16 v[60:63], v[220:223], v[204:207], v[60:63]
    ds_read_b64_tr_b16 v[178:179], v18 offset:4608
    v_mfma_f32_16x16x32_bf16 v[64:67], v[224:227], v[204:207], v[64:67]
    ds_read_b64_tr_b16 v[180:181], v19 offset:4096
    v_mfma_f32_16x16x32_bf16 v[68:71], v[220:223], v[208:211], v[68:71]
    ds_read_b64_tr_b16 v[182:183], v19 offset:4608
    v_mfma_f32_16x16x32_bf16 v[72:75], v[224:227], v[208:211], v[72:75]
    ds_read_b128 v[160:163], v15 offset:2048
    v_mfma_f32_16x16x32_bf16 v[76:79], v[220:223], v[212:215], v[76:79]
    ds_read_b128 v[164:167], v15 offset:4096
    v_mfma_f32_16x16x32_bf16 v[80:83], v[224:227], v[212:215], v[80:83]
    ds_read_b128 v[168:171], v15 offset:6144
    v_mfma_f32_16x16x32_bf16 v[84:87], v[228:231], v[200:203], v[84:87]
    ds_read_b64_tr_b16 v[184:185], v18 offset:12288
    v_mfma_f32_16x16x32_bf16 v[88:91], v[232:235], v[200:203], v[88:91]
    ds_read_b64_tr_b16 v[186:187], v18 offset:12800
    v_mfma_f32_16x16x32_bf16 v[92:95], v[228:231], v[204:207], v[92:95]
    ds_read_b64_tr_b16 v[188:189], v19 offset:12288
    v_mfma_f32_16x16x32_bf16 v[96:99], v[232:235], v[204:207], v[96:99]
    ds_read_b64_tr_b16 v[190:191], v19 offset:12800
    v_mfma_f32_16x16x32_bf16 v[100:103], v[228:231], v[208:211], v[100:103]
    ds_read_b128 v[172:175], v17
    v_mfma_f32_16x16x32_bf16 v[104:107], v[232:235], v[208:211], v[104:107]
    ds_read_b64_tr_b16 v[192:193], v18 offset:20480
    v_mfma_f32_16x16x32_bf16 v[108:111], v[228:231], v[212:215], v[108:111]
    ds_read_b64_tr_b16 v[194:195], v18 offset:20992
    v_mfma_f32_16x16x32_bf16 v[112:115], v[232:235], v[212:215], v[112:115]
    ds_read_b64_tr_b16 v[196:197], v19 offset:20480
    v_mfma_f32_16x16x32_bf16 v[148:151], v[228:231], v[216:219], v[148:151]
    ds_read_b64_tr_b16 v[198:199], v19 offset:20992
    v_mfma_f32_16x16x32_bf16 v[152:155], v[232:235], v[216:219], v[152:155]
    s_add_u32 s56, s56, 43008
    v_mfma_f32_16x16x32_bf16 v[116:119], v[200:203], v[236:239], v[116:119]
    s_cmp_eq_u32 s56, 129024
    v_mfma_f32_16x16x32_bf16 v[120:123], v[200:203], v[240:243], v[120:123]
    s_cselect_b32 s56, 0, s56
    v_mfma_f32_16x16x32_bf16 v[124:127], v[204:207], v[236:239], v[124:127]
    v_add_u32 v14, s56, v8
    v_mfma_f32_16x16x32_bf16 v[128:131], v[204:207], v[240:243], v[128:131]
    v_add_u32 v16, s56, v10
    v_mfma_f32_16x16x32_bf16 v[132:135], v[208:211], v[236:239], v[132:135]
    v_add_u32 v18, s56, v12
    v_mfma_f32_16x16x32_bf16 v[136:139], v[208:211], v[240:243], v[136:139]
    v_add_u32 v19, s56, v13
    v_mfma_f32_16x16x32_bf16 v[140:143], v[212:215], v[236:239], v[140:143]
    v_add_u32 v15, s56, v9
    v_mfma_f32_16x16x32_bf16 v[144:147], v[212:215], v[240:243], v[144:147]
    v_add_u32 v17, s56, v11
    s_cmp_lt_u32 s55, 15
    s_cbranch_scc1 k1_kernel_loop0
    s_waitcnt lgkmcnt(0)
    s_barrier
    v_mfma_f32_16x16x32_bf16 v[92:95], v[184:187], v[160:163], v[92:95]
    v_mfma_f32_16x16x32_bf16 v[96:99], v[188:191], v[160:163], v[96:99]
    v_mfma_f32_16x16x32_bf16 v[108:111], v[184:187], v[168:171], v[108:111]
    v_mfma_f32_16x16x32_bf16 v[112:115], v[188:191], v[168:171], v[112:115]
    v_mfma_f32_16x16x32_bf16 v[124:127], v[160:163], v[192:195], v[124:127]
    v_mfma_f32_16x16x32_bf16 v[128:131], v[160:163], v[196:199], v[128:131]
    v_mfma_f32_16x16x32_bf16 v[140:143], v[168:171], v[192:195], v[140:143]
    v_mfma_f32_16x16x32_bf16 v[144:147], v[168:171], v[196:199], v[144:147]
    v_mfma_f32_16x16x32_bf16 v[148:151], v[184:187], v[172:175], v[148:151]
    v_mfma_f32_16x16x32_bf16 v[152:155], v[188:191], v[172:175], v[152:155]
    v_cvt_pk_bf16_f32 v208, v92, v93
    v_cvt_pk_bf16_f32 v209, v94, v95
    v_mfma_f32_16x16x32_bf16 v[84:87], v[184:187], v[156:159], v[84:87]
    v_cvt_pk_bf16_f32 v210, v96, v97
    v_cvt_pk_bf16_f32 v211, v98, v99
    v_mfma_f32_16x16x32_bf16 v[88:91], v[188:191], v[156:159], v[88:91]
    ds_write_b128 v21, v[208:211] offset:0
    v_cvt_pk_bf16_f32 v220, v108, v109
    v_mfma_f32_16x16x32_bf16 v[100:103], v[184:187], v[164:167], v[100:103]
    v_cvt_pk_bf16_f32 v221, v110, v111
    v_cvt_pk_bf16_f32 v222, v112, v113
    v_mfma_f32_16x16x32_bf16 v[104:107], v[188:191], v[164:167], v[104:107]
    v_cvt_pk_bf16_f32 v223, v114, v115
    ds_write_b128 v21, v[220:223] offset:1024
    v_mfma_f32_16x16x32_bf16 v[52:55], v[176:179], v[156:159], v[52:55]
    v_cvt_pk_bf16_f32 v228, v124, v125
    v_cvt_pk_bf16_f32 v229, v126, v127
    v_mfma_f32_16x16x32_bf16 v[56:59], v[180:183], v[156:159], v[56:59]
    ds_write_b64 v22, v[228:229] offset:2048
    v_cvt_pk_bf16_f32 v234, v128, v129
    v_mfma_f32_16x16x32_bf16 v[60:63], v[176:179], v[160:163], v[60:63]
    v_cvt_pk_bf16_f32 v235, v130, v131
    ds_write_b64 v22, v[234:235] offset:2560
    v_mfma_f32_16x16x32_bf16 v[64:67], v[180:183], v[160:163], v[64:67]
    v_cvt_pk_bf16_f32 v240, v140, v141
    v_cvt_pk_bf16_f32 v241, v142, v143
    v_mfma_f32_16x16x32_bf16 v[68:71], v[176:179], v[164:167], v[68:71]
    ds_write_b64 v22, v[240:241] offset:3072
    v_cvt_pk_bf16_f32 v246, v144, v145
    v_mfma_f32_16x16x32_bf16 v[72:75], v[180:183], v[164:167], v[72:75]
    v_cvt_pk_bf16_f32 v247, v146, v147
    ds_write_b64 v22, v[246:247] offset:3584
    v_mfma_f32_16x16x32_bf16 v[76:79], v[176:179], v[168:171], v[76:79]
    v_cvt_pk_bf16_f32 v200, v148, v149
    v_cvt_pk_bf16_f32 v201, v150, v151
    v_mfma_f32_16x16x32_bf16 v[80:83], v[180:183], v[168:171], v[80:83]
    v_cvt_pk_bf16_f32 v202, v152, v153
    v_cvt_pk_bf16_f32 v203, v154, v155
    v_mfma_f32_16x16x32_bf16 v[116:119], v[156:159], v[192:195], v[116:119]
    v_cvt_pk_bf16_f32 v212, v148, v149
    v_cvt_pk_bf16_f32 v213, v150, v151
    v_mfma_f32_16x16x32_bf16 v[120:123], v[156:159], v[196:199], v[120:123]
    v_cvt_pk_bf16_f32 v214, v152, v153
    v_cvt_pk_bf16_f32 v215, v154, v155
    v_mfma_f32_16x16x32_bf16 v[132:135], v[164:167], v[192:195], v[132:135]
    v_cvt_pk_bf16_f32 v204, v84, v85
    v_cvt_pk_bf16_f32 v205, v86, v87
    v_mfma_f32_16x16x32_bf16 v[136:139], v[164:167], v[196:199], v[136:139]
    v_cvt_pk_bf16_f32 v206, v88, v89
    v_cvt_pk_bf16_f32 v207, v90, v91
    v_cvt_pk_bf16_f32 v216, v100, v101
    v_cvt_pk_bf16_f32 v217, v102, v103
    v_cvt_pk_bf16_f32 v218, v104, v105
    v_cvt_pk_bf16_f32 v219, v106, v107
    s_waitcnt lgkmcnt(0)
    s_barrier
    ds_read_b64 v[224:225], v22 offset:4096
    ds_read_b64 v[230:231], v22 offset:4608
    ds_read_b64 v[236:237], v22 offset:4096
    ds_read_b64 v[242:243], v22 offset:4608
    s_branch k1_kernel_attn
k1_kernel_first1:
    v_mfma_f32_16x16x32_bf16 v[52:55], v[220:223], v[200:203], 0
    ds_read_b128 v[156:159], v15 offset:0
    v_mfma_f32_16x16x32_bf16 v[56:59], v[224:227], v[200:203], 0
    ds_read_b64_tr_b16 v[176:177], v18 offset:4096
    v_mfma_f32_16x16x32_bf16 v[60:63], v[220:223], v[204:207], 0
    ds_read_b64_tr_b16 v[178:179], v18 offset:4608
    v_mfma_f32_16x16x32_bf16 v[64:67], v[224:227], v[204:207], 0
    ds_read_b64_tr_b16 v[180:181], v19 offset:4096
    v_mfma_f32_16x16x32_bf16 v[68:71], v[220:223], v[208:211], 0
    ds_read_b64_tr_b16 v[182:183], v19 offset:4608
    v_mfma_f32_16x16x32_bf16 v[72:75], v[224:227], v[208:211], 0
    ds_read_b128 v[160:163], v15 offset:2048
    v_mfma_f32_16x16x32_bf16 v[76:79], v[220:223], v[212:215], 0
    ds_read_b128 v[164:167], v15 offset:4096
    v_mfma_f32_16x16x32_bf16 v[80:83], v[224:227], v[212:215], 0
    ds_read_b128 v[168:171], v15 offset:6144
    v_mfma_f32_16x16x32_bf16 v[84:87], v[228:231], v[200:203], 0
    ds_read_b64_tr_b16 v[184:185], v18 offset:12288
    v_mfma_f32_16x16x32_bf16 v[88:91], v[232:235], v[200:203], 0
    ds_read_b64_tr_b16 v[186:187], v18 offset:12800
    v_mfma_f32_16x16x32_bf16 v[92:95], v[228:231], v[204:207], 0
    ds_read_b64_tr_b16 v[188:189], v19 offset:12288
    v_mfma_f32_16x16x32_bf16 v[96:99], v[232:235], v[204:207], 0
    ds_read_b64_tr_b16 v[190:191], v19 offset:12800
    v_mfma_f32_16x16x32_bf16 v[100:103], v[228:231], v[208:211], 0
    ds_read_b128 v[172:175], v17
    v_mfma_f32_16x16x32_bf16 v[104:107], v[232:235], v[208:211], 0
    ds_read_b64_tr_b16 v[192:193], v18 offset:20480
    v_mfma_f32_16x16x32_bf16 v[108:111], v[228:231], v[212:215], 0
    ds_read_b64_tr_b16 v[194:195], v18 offset:20992
    v_mfma_f32_16x16x32_bf16 v[112:115], v[232:235], v[212:215], 0
    ds_read_b64_tr_b16 v[196:197], v19 offset:20480
    v_mfma_f32_16x16x32_bf16 v[116:119], v[200:203], v[236:239], 0
    ds_read_b64_tr_b16 v[198:199], v19 offset:20992
    v_mfma_f32_16x16x32_bf16 v[120:123], v[200:203], v[240:243], 0
    s_add_u32 s56, s56, 43008
    v_mfma_f32_16x16x32_bf16 v[124:127], v[204:207], v[236:239], 0
    s_cmp_eq_u32 s56, 129024
    v_mfma_f32_16x16x32_bf16 v[128:131], v[204:207], v[240:243], 0
    s_cselect_b32 s56, 0, s56
    v_mfma_f32_16x16x32_bf16 v[132:135], v[208:211], v[236:239], 0
    v_add_u32 v14, s56, v8
    v_mfma_f32_16x16x32_bf16 v[136:139], v[208:211], v[240:243], 0
    v_add_u32 v16, s56, v10
    v_mfma_f32_16x16x32_bf16 v[140:143], v[212:215], v[236:239], 0
    v_add_u32 v18, s56, v12
    v_mfma_f32_16x16x32_bf16 v[144:147], v[212:215], v[240:243], 0
    v_add_u32 v19, s56, v13
    v_mfma_f32_16x16x32_bf16 v[148:151], v[216:219], v[236:239], 0
    v_add_u32 v15, s56, v9
    v_mfma_f32_16x16x32_bf16 v[152:155], v[216:219], v[240:243], 0
    v_add_u32 v17, s56, v11
k1_kernel_loop1:
    s_waitcnt lgkmcnt(0)
    s_barrier
    v_mfma_f32_16x16x32_bf16 v[52:55], v[176:179], v[156:159], v[52:55]
    ds_read_b128 v[200:203], v14 offset:0
    v_mfma_f32_16x16x32_bf16 v[56:59], v[180:183], v[156:159], v[56:59]
    ds_read_b64_tr_b16 v[220:221], v18 offset:0
    v_mfma_f32_16x16x32_bf16 v[60:63], v[176:179], v[160:163], v[60:63]
    ds_read_b64_tr_b16 v[222:223], v18 offset:512
    v_mfma_f32_16x16x32_bf16 v[64:67], v[180:183], v[160:163], v[64:67]
    ds_read_b64_tr_b16 v[224:225], v19 offset:0
    v_mfma_f32_16x16x32_bf16 v[68:71], v[176:179], v[164:167], v[68:71]
    ds_read_b64_tr_b16 v[226:227], v19 offset:512
    v_mfma_f32_16x16x32_bf16 v[72:75], v[180:183], v[164:167], v[72:75]
    ds_read_b128 v[204:207], v14 offset:2048
    v_mfma_f32_16x16x32_bf16 v[76:79], v[176:179], v[168:171], v[76:79]
    ds_read_b128 v[208:211], v14 offset:4096
    v_mfma_f32_16x16x32_bf16 v[80:83], v[180:183], v[168:171], v[80:83]
    ds_read_b128 v[212:215], v14 offset:6144
    v_mfma_f32_16x16x32_bf16 v[84:87], v[184:187], v[156:159], v[84:87]
    ds_read_b64_tr_b16 v[228:229], v18 offset:8192
    v_mfma_f32_16x16x32_bf16 v[88:91], v[188:191], v[156:159], v[88:91]
    ds_read_b64_tr_b16 v[230:231], v18 offset:8704
    v_mfma_f32_16x16x32_bf16 v[92:95], v[184:187], v[160:163], v[92:95]
    ds_read_b64_tr_b16 v[232:233], v19 offset:8192
    v_mfma_f32_16x16x32_bf16 v[96:99], v[188:191], v[160:163], v[96:99]
    ds_read_b64_tr_b16 v[234:235], v19 offset:8704
    v_mfma_f32_16x16x32_bf16 v[100:103], v[184:187], v[164:167], v[100:103]
    ds_read_b128 v[216:219], v16
    v_mfma_f32_16x16x32_bf16 v[104:107], v[188:191], v[164:167], v[104:107]
    ds_read_b64_tr_b16 v[236:237], v18 offset:16384
    v_mfma_f32_16x16x32_bf16 v[108:111], v[184:187], v[168:171], v[108:111]
    ds_read_b64_tr_b16 v[238:239], v18 offset:16896
    v_mfma_f32_16x16x32_bf16 v[112:115], v[188:191], v[168:171], v[112:115]
    ds_read_b64_tr_b16 v[240:241], v19 offset:16384
    v_mfma_f32_16x16x32_bf16 v[116:119], v[156:159], v[192:195], v[116:119]
    ds_read_b64_tr_b16 v[242:243], v19 offset:16896
    v_mfma_f32_16x16x32_bf16 v[120:123], v[156:159], v[196:199], v[120:123]
    s_add_u32 s55, s55, 1
    v_mfma_f32_16x16x32_bf16 v[124:127], v[160:163], v[192:195], v[124:127]
    v_mfma_f32_16x16x32_bf16 v[128:131], v[160:163], v[196:199], v[128:131]
    v_mfma_f32_16x16x32_bf16 v[132:135], v[164:167], v[192:195], v[132:135]
    v_mfma_f32_16x16x32_bf16 v[136:139], v[164:167], v[196:199], v[136:139]
    v_mfma_f32_16x16x32_bf16 v[140:143], v[168:171], v[192:195], v[140:143]
    v_mfma_f32_16x16x32_bf16 v[144:147], v[168:171], v[196:199], v[144:147]
    v_mfma_f32_16x16x32_bf16 v[148:151], v[172:175], v[192:195], v[148:151]
    v_mfma_f32_16x16x32_bf16 v[152:155], v[172:175], v[196:199], v[152:155]
    s_waitcnt lgkmcnt(0)
    v_mfma_f32_16x16x32_bf16 v[52:55], v[220:223], v[200:203], v[52:55]
    ds_read_b128 v[156:159], v15 offset:0
    v_mfma_f32_16x16x32_bf16 v[56:59], v[224:227], v[200:203], v[56:59]
    ds_read_b64_tr_b16 v[176:177], v18 offset:4096
    v_mfma_f32_16x16x32_bf16 v[60:63], v[220:223], v[204:207], v[60:63]
    ds_read_b64_tr_b16 v[178:179], v18 offset:4608
    v_mfma_f32_16x16x32_bf16 v[64:67], v[224:227], v[204:207], v[64:67]
    ds_read_b64_tr_b16 v[180:181], v19 offset:4096
    v_mfma_f32_16x16x32_bf16 v[68:71], v[220:223], v[208:211], v[68:71]
    ds_read_b64_tr_b16 v[182:183], v19 offset:4608
    v_mfma_f32_16x16x32_bf16 v[72:75], v[224:227], v[208:211], v[72:75]
    ds_read_b128 v[160:163], v15 offset:2048
    v_mfma_f32_16x16x32_bf16 v[76:79], v[220:223], v[212:215], v[76:79]
    ds_read_b128 v[164:167], v15 offset:4096
    v_mfma_f32_16x16x32_bf16 v[80:83], v[224:227], v[212:215], v[80:83]
    ds_read_b128 v[168:171], v15 offset:6144
    v_mfma_f32_16x16x32_bf16 v[84:87], v[228:231], v[200:203], v[84:87]
    ds_read_b64_tr_b16 v[184:185], v18 offset:12288
    v_mfma_f32_16x16x32_bf16 v[88:91], v[232:235], v[200:203], v[88:91]
    ds_read_b64_tr_b16 v[186:187], v18 offset:12800
    v_mfma_f32_16x16x32_bf16 v[92:95], v[228:231], v[204:207], v[92:95]
    ds_read_b64_tr_b16 v[188:189], v19 offset:12288
    v_mfma_f32_16x16x32_bf16 v[96:99], v[232:235], v[204:207], v[96:99]
    ds_read_b64_tr_b16 v[190:191], v19 offset:12800
    v_mfma_f32_16x16x32_bf16 v[100:103], v[228:231], v[208:211], v[100:103]
    ds_read_b128 v[172:175], v17
    v_mfma_f32_16x16x32_bf16 v[104:107], v[232:235], v[208:211], v[104:107]
    ds_read_b64_tr_b16 v[192:193], v18 offset:20480
    v_mfma_f32_16x16x32_bf16 v[108:111], v[228:231], v[212:215], v[108:111]
    ds_read_b64_tr_b16 v[194:195], v18 offset:20992
    v_mfma_f32_16x16x32_bf16 v[112:115], v[232:235], v[212:215], v[112:115]
    ds_read_b64_tr_b16 v[196:197], v19 offset:20480
    v_mfma_f32_16x16x32_bf16 v[116:119], v[200:203], v[236:239], v[116:119]
    ds_read_b64_tr_b16 v[198:199], v19 offset:20992
    v_mfma_f32_16x16x32_bf16 v[120:123], v[200:203], v[240:243], v[120:123]
    s_add_u32 s56, s56, 43008
    v_mfma_f32_16x16x32_bf16 v[124:127], v[204:207], v[236:239], v[124:127]
    s_cmp_eq_u32 s56, 129024
    v_mfma_f32_16x16x32_bf16 v[128:131], v[204:207], v[240:243], v[128:131]
    s_cselect_b32 s56, 0, s56
    v_mfma_f32_16x16x32_bf16 v[132:135], v[208:211], v[236:239], v[132:135]
    v_add_u32 v14, s56, v8
    v_mfma_f32_16x16x32_bf16 v[136:139], v[208:211], v[240:243], v[136:139]
    v_add_u32 v16, s56, v10
    v_mfma_f32_16x16x32_bf16 v[140:143], v[212:215], v[236:239], v[140:143]
    v_add_u32 v18, s56, v12
    v_mfma_f32_16x16x32_bf16 v[144:147], v[212:215], v[240:243], v[144:147]
    v_add_u32 v19, s56, v13
    v_mfma_f32_16x16x32_bf16 v[148:151], v[216:219], v[236:239], v[148:151]
    v_add_u32 v15, s56, v9
    v_mfma_f32_16x16x32_bf16 v[152:155], v[216:219], v[240:243], v[152:155]
    v_add_u32 v17, s56, v11
    s_cmp_lt_u32 s55, 15
    s_cbranch_scc1 k1_kernel_loop1
    s_waitcnt lgkmcnt(0)
    s_barrier
    v_mfma_f32_16x16x32_bf16 v[148:151], v[172:175], v[192:195], v[148:151]
    v_mfma_f32_16x16x32_bf16 v[152:155], v[172:175], v[196:199], v[152:155]
    v_mfma_f32_16x16x32_bf16 v[92:95], v[184:187], v[160:163], v[92:95]
    v_mfma_f32_16x16x32_bf16 v[96:99], v[188:191], v[160:163], v[96:99]
    v_mfma_f32_16x16x32_bf16 v[108:111], v[184:187], v[168:171], v[108:111]
    v_mfma_f32_16x16x32_bf16 v[112:115], v[188:191], v[168:171], v[112:115]
    v_mfma_f32_16x16x32_bf16 v[124:127], v[160:163], v[192:195], v[124:127]
    v_mfma_f32_16x16x32_bf16 v[128:131], v[160:163], v[196:199], v[128:131]
    v_mfma_f32_16x16x32_bf16 v[140:143], v[168:171], v[192:195], v[140:143]
    v_mfma_f32_16x16x32_bf16 v[144:147], v[168:171], v[196:199], v[144:147]
    v_cvt_pk_bf16_f32 v248, v148, v149
    v_cvt_pk_bf16_f32 v249, v150, v151
    v_mfma_f32_16x16x32_bf16 v[84:87], v[184:187], v[156:159], v[84:87]
    ds_write_b64 v22, v[248:249] offset:4096
    v_cvt_pk_bf16_f32 v250, v152, v153
    v_mfma_f32_16x16x32_bf16 v[88:91], v[188:191], v[156:159], v[88:91]
    v_cvt_pk_bf16_f32 v251, v154, v155
    ds_write_b64 v22, v[250:251] offset:4608
    v_mfma_f32_16x16x32_bf16 v[100:103], v[184:187], v[164:167], v[100:103]
    v_cvt_pk_bf16_f32 v208, v92, v93
    v_cvt_pk_bf16_f32 v209, v94, v95
    v_mfma_f32_16x16x32_bf16 v[104:107], v[188:191], v[164:167], v[104:107]
    v_cvt_pk_bf16_f32 v210, v96, v97
    v_cvt_pk_bf16_f32 v211, v98, v99
    v_mfma_f32_16x16x32_bf16 v[52:55], v[176:179], v[156:159], v[52:55]
    v_cvt_pk_bf16_f32 v220, v108, v109
    v_cvt_pk_bf16_f32 v221, v110, v111
    v_mfma_f32_16x16x32_bf16 v[56:59], v[180:183], v[156:159], v[56:59]
    v_cvt_pk_bf16_f32 v222, v112, v113
    v_cvt_pk_bf16_f32 v223, v114, v115
    v_mfma_f32_16x16x32_bf16 v[60:63], v[176:179], v[160:163], v[60:63]
    v_cvt_pk_bf16_f32 v228, v124, v125
    v_cvt_pk_bf16_f32 v229, v126, v127
    v_mfma_f32_16x16x32_bf16 v[64:67], v[180:183], v[160:163], v[64:67]
    v_cvt_pk_bf16_f32 v234, v128, v129
    v_cvt_pk_bf16_f32 v235, v130, v131
    v_mfma_f32_16x16x32_bf16 v[68:71], v[176:179], v[164:167], v[68:71]
    v_cvt_pk_bf16_f32 v240, v140, v141
    v_cvt_pk_bf16_f32 v241, v142, v143
    v_mfma_f32_16x16x32_bf16 v[72:75], v[180:183], v[164:167], v[72:75]
    v_cvt_pk_bf16_f32 v246, v144, v145
    v_cvt_pk_bf16_f32 v247, v146, v147
    v_mfma_f32_16x16x32_bf16 v[76:79], v[176:179], v[168:171], v[76:79]
    v_cvt_pk_bf16_f32 v204, v84, v85
    v_cvt_pk_bf16_f32 v205, v86, v87
    v_mfma_f32_16x16x32_bf16 v[80:83], v[180:183], v[168:171], v[80:83]
    v_cvt_pk_bf16_f32 v206, v88, v89
    v_cvt_pk_bf16_f32 v207, v90, v91
    v_mfma_f32_16x16x32_bf16 v[116:119], v[156:159], v[192:195], v[116:119]
    v_cvt_pk_bf16_f32 v216, v100, v101
    v_cvt_pk_bf16_f32 v217, v102, v103
    v_mfma_f32_16x16x32_bf16 v[120:123], v[156:159], v[196:199], v[120:123]
    v_cvt_pk_bf16_f32 v218, v104, v105
    v_cvt_pk_bf16_f32 v219, v106, v107
    v_mfma_f32_16x16x32_bf16 v[132:135], v[164:167], v[192:195], v[132:135]
    v_mfma_f32_16x16x32_bf16 v[136:139], v[164:167], v[196:199], v[136:139]
    s_waitcnt lgkmcnt(0)
    s_barrier
    ds_read_b128 v[200:203], v21 offset:0
    ds_read_b128 v[212:215], v21 offset:1024
    ds_read_b64 v[224:225], v22 offset:2048
    ds_read_b64 v[230:231], v22 offset:2560
    ds_read_b64 v[236:237], v22 offset:3072
    ds_read_b64 v[242:243], v22 offset:3584
k1_kernel_attn:
    v_cvt_pk_bf16_f32 v160, v60, v61
    v_cvt_pk_bf16_f32 v161, v62, v63
    v_cvt_pk_bf16_f32 v162, v64, v65
    v_cvt_pk_bf16_f32 v163, v66, v67
    v_cvt_pk_bf16_f32 v156, v52, v53
    v_cvt_pk_bf16_f32 v157, v54, v55
    v_cvt_pk_bf16_f32 v158, v56, v57
    v_cvt_pk_bf16_f32 v159, v58, v59
    v_cvt_pk_bf16_f32 v168, v76, v77
    v_cvt_pk_bf16_f32 v169, v78, v79
    v_cvt_pk_bf16_f32 v170, v80, v81
    v_cvt_pk_bf16_f32 v171, v82, v83
    v_cvt_pk_bf16_f32 v164, v68, v69
    v_cvt_pk_bf16_f32 v165, v70, v71
    v_cvt_pk_bf16_f32 v166, v72, v73
    v_cvt_pk_bf16_f32 v167, v74, v75
    s_nop 1
    v_mfma_f32_16x16x32_bf16 v[72:75], v[208:211], v[160:163], v[32:35]
    v_mfma_f32_16x16x32_bf16 v[56:59], v[204:207], v[160:163], v[36:39]
    v_mfma_f32_16x16x32_bf16 v[80:83], v[220:223], v[168:171], v[32:35]
    v_mfma_f32_16x16x32_bf16 v[64:67], v[216:219], v[168:171], v[36:39]
    v_mfma_f32_16x16x32_bf16 v[68:71], v[204:207], v[156:159], v[32:35]
    v_mfma_f32_16x16x32_bf16 v[76:79], v[216:219], v[164:167], v[32:35]
    s_waitcnt lgkmcnt(4)
    v_mfma_f32_16x16x32_bf16 v[52:55], v[200:203], v[156:159], v[40:43]
    v_mfma_f32_16x16x32_bf16 v[60:63], v[212:215], v[164:167], v[44:47]
    v_cvt_pk_bf16_f32 v226, v116, v117
    v_cvt_pk_bf16_f32 v227, v118, v119
    v_cvt_pk_bf16_f32 v232, v120, v121
    v_cvt_pk_bf16_f32 v233, v122, v123
    v_cvt_pk_bf16_f32 v238, v132, v133
    v_cvt_pk_bf16_f32 v239, v134, v135
    v_cvt_pk_bf16_f32 v244, v136, v137
    v_cvt_pk_bf16_f32 v245, v138, v139
    v_max_f32 v72, v72, v56
    v_max_f32 v73, v73, v57
    v_max_f32 v74, v74, v58
    v_max_f32 v75, v75, v59
    v_cvt_pk_bf16_f32 v72, 0, v72
    v_cvt_pk_bf16_f32 v73, 0, v73
    v_cvt_pk_bf16_f32 v74, 0, v74
    v_cvt_pk_bf16_f32 v75, 0, v75
    v_mul_f32 v72, s62, v72
    v_mul_f32 v73, s62, v73
    v_mul_f32 v74, s62, v74
    v_mul_f32 v75, s62, v75
    v_cvt_pk_bf16_f32 v72, 0, v72
    v_cvt_pk_bf16_f32 v73, 0, v73
    v_cvt_pk_bf16_f32 v74, 0, v74
    v_cvt_pk_bf16_f32 v75, 0, v75
    v_max_f32 v101, v72, v73
    v_max3_f32 v101, v74, v75, v101
    v_max_f32 v80, v80, v64
    v_max_f32 v81, v81, v65
    v_max_f32 v82, v82, v66
    v_max_f32 v83, v83, v67
    v_cvt_pk_bf16_f32 v80, 0, v80
    v_cvt_pk_bf16_f32 v81, 0, v81
    v_cvt_pk_bf16_f32 v82, 0, v82
    v_cvt_pk_bf16_f32 v83, 0, v83
    v_mul_f32 v80, s62, v80
    v_mul_f32 v81, s62, v81
    v_mul_f32 v82, s62, v82
    v_mul_f32 v83, s62, v83
    v_cvt_pk_bf16_f32 v80, 0, v80
    v_cvt_pk_bf16_f32 v81, 0, v81
    v_cvt_pk_bf16_f32 v82, 0, v82
    v_cvt_pk_bf16_f32 v83, 0, v83
    v_max_f32 v103, v80, v81
    v_max3_f32 v103, v82, v83, v103
    v_max_f32 v68, v68, v52
    v_max_f32 v69, v69, v53
    v_max_f32 v70, v70, v54
    v_max_f32 v71, v71, v55
    v_cvt_pk_bf16_f32 v68, 0, v68
    v_cvt_pk_bf16_f32 v69, 0, v69
    v_cvt_pk_bf16_f32 v70, 0, v70
    v_cvt_pk_bf16_f32 v71, 0, v71
    v_mul_f32 v68, s62, v68
    v_mul_f32 v69, s62, v69
    v_mul_f32 v70, s62, v70
    v_mul_f32 v71, s62, v71
    v_cvt_pk_bf16_f32 v68, 0, v68
    v_cvt_pk_bf16_f32 v69, 0, v69
    v_cvt_pk_bf16_f32 v70, 0, v70
    v_cvt_pk_bf16_f32 v71, 0, v71
    v_max_f32 v100, v68, v69
    v_max3_f32 v100, v70, v71, v100
    v_max_f32 v76, v76, v60
    v_max_f32 v77, v77, v61
    v_max_f32 v78, v78, v62
    v_max_f32 v79, v79, v63
    v_cvt_pk_bf16_f32 v76, 0, v76
    v_cvt_pk_bf16_f32 v77, 0, v77
    v_cvt_pk_bf16_f32 v78, 0, v78
    v_cvt_pk_bf16_f32 v79, 0, v79
    v_mul_f32 v76, s62, v76
    v_mul_f32 v77, s62, v77
    v_mul_f32 v78, s62, v78
    v_mul_f32 v79, s62, v79
    v_cvt_pk_bf16_f32 v76, 0, v76
    v_cvt_pk_bf16_f32 v77, 0, v77
    v_cvt_pk_bf16_f32 v78, 0, v78
    v_cvt_pk_bf16_f32 v79, 0, v79
    v_max_f32 v102, v76, v77
    v_max3_f32 v102, v78, v79, v102
    v_mov_b32 v105, v101
    v_mov_b32 v107, v103
    v_mov_b32 v104, v100
    v_mov_b32 v106, v102
    s_nop 0
    v_permlane32_swap_b32 v101, v105
    v_permlane32_swap_b32 v103, v107
    v_permlane32_swap_b32 v100, v104
    v_permlane32_swap_b32 v102, v106
    v_max_f32 v101, v101, v105
    v_max_f32 v103, v103, v107
    v_max_f32 v100, v100, v104
    v_max_f32 v102, v102, v106
    v_mov_b32 v105, v101
    v_mov_b32 v107, v103
    v_mov_b32 v104, v100
    v_mov_b32 v106, v102
    s_nop 0
    v_permlane16_swap_b32 v101, v105
    v_permlane16_swap_b32 v103, v107
    v_permlane16_swap_b32 v100, v104
    v_permlane16_swap_b32 v102, v106
    v_max_f32 v101, v101, v105
    v_max_f32 v103, v103, v107
    v_max_f32 v100, v100, v104
    v_max_f32 v102, v102, v106
    v_mul_f32 v101, s63, v101
    v_mul_f32 v103, s63, v103
    v_mul_f32 v100, s63, v100
    v_mul_f32 v102, s63, v102
    v_fma_f32 v72, v72, s63, -v101
    v_fma_f32 v73, v73, s63, -v101
    v_fma_f32 v74, v74, s63, -v101
    v_fma_f32 v75, v75, s63, -v101
    v_exp_f32 v72, v72
    v_exp_f32 v73, v73
    v_exp_f32 v74, v74
    v_exp_f32 v75, v75
    v_fma_f32 v80, v80, s63, -v103
    v_fma_f32 v81, v81, s63, -v103
    v_fma_f32 v82, v82, s63, -v103
    v_fma_f32 v83, v83, s63, -v103
    v_exp_f32 v80, v80
    v_exp_f32 v81, v81
    v_exp_f32 v82, v82
    v_exp_f32 v83, v83
    v_fma_f32 v68, v68, s63, -v100
    v_fma_f32 v69, v69, s63, -v100
    v_fma_f32 v70, v70, s63, -v100
    v_fma_f32 v71, v71, s63, -v100
    v_exp_f32 v68, v68
    v_exp_f32 v69, v69
    v_exp_f32 v70, v70
    v_exp_f32 v71, v71
    v_fma_f32 v76, v76, s63, -v102
    v_fma_f32 v77, v77, s63, -v102
    v_fma_f32 v78, v78, s63, -v102
    v_fma_f32 v79, v79, s63, -v102
    v_exp_f32 v76, v76
    v_exp_f32 v77, v77
    v_exp_f32 v78, v78
    v_exp_f32 v79, v79
    s_nop 0
    v_add_f32 v101, v72, v73
    v_add_f32 v105, v74, v75
    v_add_f32 v101, v101, v105
    v_add_f32 v103, v80, v81
    v_add_f32 v107, v82, v83
    v_add_f32 v103, v103, v107
    v_add_f32 v100, v68, v69
    v_add_f32 v104, v70, v71
    v_add_f32 v100, v100, v104
    v_add_f32 v102, v76, v77
    v_add_f32 v106, v78, v79
    v_add_f32 v102, v102, v106
    v_mov_b32 v105, v101
    v_mov_b32 v107, v103
    v_mov_b32 v104, v100
    v_mov_b32 v106, v102
    s_nop 0
    v_permlane32_swap_b32 v101, v105
    v_permlane32_swap_b32 v103, v107
    v_permlane32_swap_b32 v100, v104
    v_permlane32_swap_b32 v102, v106
    v_add_f32 v101, v101, v105
    v_add_f32 v103, v103, v107
    v_add_f32 v100, v100, v104
    v_add_f32 v102, v102, v106
    v_mov_b32 v105, v101
    v_mov_b32 v107, v103
    v_mov_b32 v104, v100
    v_mov_b32 v106, v102
    s_nop 0
    v_permlane16_swap_b32 v101, v105
    v_permlane16_swap_b32 v103, v107
    v_permlane16_swap_b32 v100, v104
    v_permlane16_swap_b32 v102, v106
    v_add_f32 v101, v101, v105
    v_add_f32 v103, v103, v107
    v_add_f32 v100, v100, v104
    v_add_f32 v102, v102, v106
    v_rcp_f32 v101, v101
    v_rcp_f32 v103, v103
    v_rcp_f32 v100, v100
    v_rcp_f32 v102, v102
    s_waitcnt lgkmcnt(0)
    v_mul_f32 v72, v72, v101
    v_mul_f32 v73, v73, v101
    v_mul_f32 v74, v74, v101
    v_mul_f32 v75, v75, v101
    v_cvt_pk_bf16_f32 v56, v72, v73
    v_cvt_pk_bf16_f32 v57, v74, v75
    v_and_b32 v88, v56, v26
    v_and_b32 v89, v57, v27
    v_and_b32 v90, v56, v24
    v_and_b32 v91, v57, v25
    s_nop 1
    v_mfma_f32_16x16x32_bf16 v[124:127], v[226:229], v[88:91], 0
    v_mfma_f32_16x16x32_bf16 v[128:131], v[232:235], v[88:91], 0
    v_mul_f32 v80, v80, v103
    v_mul_f32 v81, v81, v103
    v_mul_f32 v82, v82, v103
    v_mul_f32 v83, v83, v103
    v_cvt_pk_bf16_f32 v64, v80, v81
    v_cvt_pk_bf16_f32 v65, v82, v83
    v_and_b32 v96, v64, v26
    v_and_b32 v97, v65, v27
    v_and_b32 v98, v64, v24
    v_and_b32 v99, v65, v25
    s_nop 1
    v_mfma_f32_16x16x32_bf16 v[140:143], v[238:241], v[96:99], 0
    v_mfma_f32_16x16x32_bf16 v[144:147], v[244:247], v[96:99], 0
    v_mul_f32 v68, v68, v100
    v_mul_f32 v69, v69, v100
    v_mul_f32 v70, v70, v100
    v_mul_f32 v71, v71, v100
    v_cvt_pk_bf16_f32 v52, v68, v69
    v_cvt_pk_bf16_f32 v53, v70, v71
    v_and_b32 v84, v52, v28
    v_and_b32 v85, v53, v29
    v_and_b32 v86, v52, v24
    v_and_b32 v87, v53, v25
    s_nop 1
    v_mfma_f32_16x16x32_bf16 v[116:119], v[224:227], v[84:87], 0
    v_mfma_f32_16x16x32_bf16 v[120:123], v[230:233], v[84:87], 0
    v_mul_f32 v76, v76, v102
    v_mul_f32 v77, v77, v102
    v_mul_f32 v78, v78, v102
    v_mul_f32 v79, v79, v102
    v_cvt_pk_bf16_f32 v60, v76, v77
    v_cvt_pk_bf16_f32 v61, v78, v79
    v_and_b32 v92, v60, v30
    v_and_b32 v93, v61, v31
    v_and_b32 v94, v60, v24
    v_and_b32 v95, v61, v25
    s_nop 1
    v_mfma_f32_16x16x32_bf16 v[132:135], v[236:239], v[92:95], 0
    v_mfma_f32_16x16x32_bf16 v[136:139], v[242:245], v[92:95], 0
    v_cvt_pk_bf16_f32 v72, v124, v125
    v_cvt_pk_bf16_f32 v73, v126, v127
    v_cvt_pk_bf16_f32 v74, v128, v129
    v_cvt_pk_bf16_f32 v75, v130, v131
    s_nop 1
    v_permlane16_swap_b32 v72, v74
    v_permlane16_swap_b32 v73, v75
    buffer_store_dwordx4 v[72:75], v20, s[24:27], 0 offen offset:128 sc1
    v_cvt_pk_bf16_f32 v80, v140, v141
    v_cvt_pk_bf16_f32 v81, v142, v143
    v_cvt_pk_bf16_f32 v82, v144, v145
    v_cvt_pk_bf16_f32 v83, v146, v147
    s_nop 1
    v_permlane16_swap_b32 v80, v82
    v_permlane16_swap_b32 v81, v83
    buffer_store_dwordx4 v[80:83], v20, s[24:27], s64 offen offset:128 sc1
    v_cvt_pk_bf16_f32 v68, v116, v117
    v_cvt_pk_bf16_f32 v69, v118, v119
    v_cvt_pk_bf16_f32 v70, v120, v121
    v_cvt_pk_bf16_f32 v71, v122, v123
    s_nop 1
    v_permlane16_swap_b32 v68, v70
    v_permlane16_swap_b32 v69, v71
    buffer_store_dwordx4 v[68:71], v20, s[24:27], 0 offen offset:0 sc1
    v_cvt_pk_bf16_f32 v76, v132, v133
    v_cvt_pk_bf16_f32 v77, v134, v135
    v_cvt_pk_bf16_f32 v78, v136, v137
    v_cvt_pk_bf16_f32 v79, v138, v139
    s_nop 1
    v_permlane16_swap_b32 v76, v78
    v_permlane16_swap_b32 v77, v79
    buffer_store_dwordx4 v[76:79], v20, s[24:27], s64 offen offset:0 sc1
k1_kernel_end:
    s_endpgm

.globl k2_kernel
.p2align 8
.type k2_kernel,@function
k2_kernel:
    s_cmp_ge_u32 s2, 256
    s_cbranch_scc1 k2_kernel_end
    s_load_dwordx2 s[4:5], s[0:1], 16
    s_load_dwordx2 s[6:7], s[0:1], 72
    s_load_dwordx2 s[8:9], s[0:1], 88
    v_lshrrev_b32 v1, 6, v0
    v_and_b32 v0, 63, v0
    s_and_b32 s35, s2, 7
    v_readfirstlane_b32 s32, v1
    s_lshr_b32 s36, s2, 3
    s_and_b32 s33, s35, 3
    s_lshl_b32 s33, s33, 2
    s_and_b32 s37, s36, 3
    s_add_u32 s33, s33, s37
    s_lshr_b32 s34, s35, 2
    s_lshl_b32 s34, s34, 3
    s_lshr_b32 s37, s36, 2
    s_add_u32 s34, s34, s37
    s_cmp_lt_u32 s32, 4
    s_cbranch_scc1 k2_kernel_compute
    s_and_b32 s38, s32, 3
    v_lshrrev_b32 v1, 3, v0
    v_and_b32 v2, 7, v0
    s_lshl_b32 s35, s33, 1
    s_lshr_b32 s36, s38, 1
    s_add_u32 s35, s35, s36
    s_and_b32 s36, s38, 1
    s_lshl_b32 s37, s35, 18
    s_lshl_b32 s41, s36, 16
    s_add_u32 s37, s37, s41
    s_lshl_b32 s41, s34, 7
    s_add_u32 s37, s37, s41
    v_lshlrev_b32 v3, 11, v1
    v_add_u32 v3, s37, v3
    v_and_b32 v4, 2, v1
    v_xor_b32 v4, v4, v2
    v_lshl_add_u32 v6, v4, 4, v3
    v_xor_b32 v4, 4, v4
    v_lshl_add_u32 v7, v4, 4, v3
    v_add_u32 v7, 15360, v7
    v_add_u32 v8, 30720, v6
    v_add_u32 v9, 30720, v7
    s_lshl_b32 s44, s38, 12
    s_lshl_b32 s37, s35, 17
    s_lshl_b32 s36, s36, 12
    s_add_u32 s37, s37, s36
    v_xor_b32 v4, v2, v1
    v_lshlrev_b32 v4, 4, v4
    v_lshl_add_u32 v5, v1, 7, v4
    v_add_u32 v5, s37, v5
    s_lshl_b32 s35, s38, 4
    v_add_u32 v3, s35, v1
    v_lshlrev_b32 v3, 11, v3
    v_add_u32 v3, s41, v3
    v_and_b32 v4, 2, v1
    v_xor_b32 v4, v4, v2
    v_lshl_add_u32 v10, v4, 4, v3
    v_xor_b32 v4, 4, v4
    v_lshl_add_u32 v11, v4, 4, v3
    v_add_u32 v11, 15360, v11
    s_lshl_b32 s45, s38, 11
    s_add_u32 s45, s45, 16384
    s_mov_b32 s46, 0
    s_lshl_b32 s46, s46, 0
    s_and_b32 s46, s46, 15
    s_waitcnt lgkmcnt(0)
    s_add_u32 s12, s8, 0
    s_addc_u32 s13, s9, 0
    s_and_b32 s13, s13, 0xffff
    s_mov_b32 s14, 4194304
    s_mov_b32 s15, 0x00020000
    s_add_u32 s20, s8, 4194304
    s_addc_u32 s21, s9, 0
    s_and_b32 s21, s21, 0xffff
    s_mov_b32 s22, 8388608
    s_mov_b32 s23, 0x00020000
    s_mov_b32 s16, s4
    s_and_b32 s17, s5, 0xffff
    s_mov_b32 s18, 2097152
    s_mov_b32 s19, 0x00020000
    s_add_u32 m0, s44, 0
    s_mov_b32 s37, 0
    buffer_load_dwordx4 v6, s[20:23], s37 offen offset:0 lds
    buffer_load_dwordx4 v7, s[20:23], s37 offen offset:1024 lds
    buffer_load_dwordx4 v8, s[20:23], s37 offen offset:2048 lds
    buffer_load_dwordx4 v9, s[20:23], s37 offen offset:3072 lds
    s_add_u32 m0, s44, 24576
    s_mov_b32 s37, 131072
    buffer_load_dwordx4 v6, s[20:23], s37 offen offset:0 lds
    buffer_load_dwordx4 v7, s[20:23], s37 offen offset:1024 lds
    buffer_load_dwordx4 v8, s[20:23], s37 offen offset:2048 lds
    buffer_load_dwordx4 v9, s[20:23], s37 offen offset:3072 lds
    s_add_u32 m0, s44, 49152
    s_lshl_b32 s35, s46, 13
    buffer_load_dwordx4 v5, s[12:15], s35 offen offset:0 lds
    buffer_load_dwordx4 v5, s[12:15], s35 offen offset:1024 lds
    buffer_load_dwordx4 v5, s[12:15], s35 offen offset:2048 lds
    buffer_load_dwordx4 v5, s[12:15], s35 offen offset:3072 lds
    s_add_u32 m0, s45, 49152
    s_lshl_b32 s35, s46, 17
    buffer_load_dwordx4 v10, s[16:19], s35 offen offset:0 lds
    buffer_load_dwordx4 v11, s[16:19], s35 offen offset:1024 lds
    s_add_u32 s46, s46, 1
    s_and_b32 s46, s46, 15
    s_waitcnt vmcnt(10)
    s_barrier
    s_add_u32 m0, s44, 73728
    s_lshl_b32 s35, s46, 13
    buffer_load_dwordx4 v5, s[12:15], s35 offen offset:0 lds
    buffer_load_dwordx4 v5, s[12:15], s35 offen offset:1024 lds
    buffer_load_dwordx4 v5, s[12:15], s35 offen offset:2048 lds
    buffer_load_dwordx4 v5, s[12:15], s35 offen offset:3072 lds
    s_add_u32 m0, s45, 73728
    s_lshl_b32 s35, s46, 17
    buffer_load_dwordx4 v10, s[16:19], s35 offen offset:0 lds
    buffer_load_dwordx4 v11, s[16:19], s35 offen offset:1024 lds
    s_add_u32 s46, s46, 1
    s_and_b32 s46, s46, 15
    s_waitcnt vmcnt(12)
    s_barrier
    s_add_u32 m0, s44, 98304
    s_lshl_b32 s35, s46, 13
    buffer_load_dwordx4 v5, s[12:15], s35 offen offset:0 lds
    buffer_load_dwordx4 v5, s[12:15], s35 offen offset:1024 lds
    buffer_load_dwordx4 v5, s[12:15], s35 offen offset:2048 lds
    buffer_load_dwordx4 v5, s[12:15], s35 offen offset:3072 lds
    s_add_u32 m0, s45, 98304
    s_lshl_b32 s35, s46, 17
    buffer_load_dwordx4 v10, s[16:19], s35 offen offset:0 lds
    buffer_load_dwordx4 v11, s[16:19], s35 offen offset:1024 lds
    s_add_u32 s46, s46, 1
    s_and_b32 s46, s46, 15
    s_waitcnt vmcnt(12)
    s_barrier
    s_add_u32 m0, s44, 122880
    s_lshl_b32 s35, s46, 13
    buffer_load_dwordx4 v5, s[12:15], s35 offen offset:0 lds
    buffer_load_dwordx4 v5, s[12:15], s35 offen offset:1024 lds
    buffer_load_dwordx4 v5, s[12:15], s35 offen offset:2048 lds
    buffer_load_dwordx4 v5, s[12:15], s35 offen offset:3072 lds
    s_add_u32 m0, s45, 122880
    s_lshl_b32 s35, s46, 17
    buffer_load_dwordx4 v10, s[16:19], s35 offen offset:0 lds
    buffer_load_dwordx4 v11, s[16:19], s35 offen offset:1024 lds
    s_add_u32 s46, s46, 1
    s_and_b32 s46, s46, 15
    s_waitcnt vmcnt(12)
    s_barrier
    s_add_u32 m0, s44, 0
    s_lshl_b32 s35, s46, 13
    buffer_load_dwordx4 v5, s[12:15], s35 offen offset:0 lds
    buffer_load_dwordx4 v5, s[12:15], s35 offen offset:1024 lds
    buffer_load_dwordx4 v5, s[12:15], s35 offen offset:2048 lds
    buffer_load_dwordx4 v5, s[12:15], s35 offen offset:3072 lds
    s_add_u32 m0, s45, 0
    s_lshl_b32 s35, s46, 17
    buffer_load_dwordx4 v10, s[16:19], s35 offen offset:0 lds
    buffer_load_dwordx4 v11, s[16:19], s35 offen offset:1024 lds
    s_add_u32 s46, s46, 1
    s_and_b32 s46, s46, 15
    s_waitcnt vmcnt(12)
    s_barrier
    s_add_u32 m0, s44, 24576
    s_lshl_b32 s35, s46, 13
    buffer_load_dwordx4 v5, s[12:15], s35 offen offset:0 lds
    buffer_load_dwordx4 v5, s[12:15], s35 offen offset:1024 lds
    buffer_load_dwordx4 v5, s[12:15], s35 offen offset:2048 lds
    buffer_load_dwordx4 v5, s[12:15], s35 offen offset:3072 lds
    s_add_u32 m0, s45, 24576
    s_lshl_b32 s35, s46, 17
    buffer_load_dwordx4 v10, s[16:19], s35 offen offset:0 lds
    buffer_load_dwordx4 v11, s[16:19], s35 offen offset:1024 lds
    s_add_u32 s46, s46, 1
    s_and_b32 s46, s46, 15
    s_waitcnt vmcnt(12)
    s_barrier
    s_add_u32 m0, s44, 49152
    s_lshl_b32 s35, s46, 13
    buffer_load_dwordx4 v5, s[12:15], s35 offen offset:0 lds
    buffer_load_dwordx4 v5, s[12:15], s35 offen offset:1024 lds
    buffer_load_dwordx4 v5, s[12:15], s35 offen offset:2048 lds
    buffer_load_dwordx4 v5, s[12:15], s35 offen offset:3072 lds
    s_add_u32 m0, s45, 49152
    s_lshl_b32 s35, s46, 17
    buffer_load_dwordx4 v10, s[16:19], s35 offen offset:0 lds
    buffer_load_dwordx4 v11, s[16:19], s35 offen offset:1024 lds
    s_add_u32 s46, s46, 1
    s_and_b32 s46, s46, 15
    s_waitcnt vmcnt(12)
    s_barrier
    s_add_u32 m0, s44, 73728
    s_lshl_b32 s35, s46, 13
    buffer_load_dwordx4 v5, s[12:15], s35 offen offset:0 lds
    buffer_load_dwordx4 v5, s[12:15], s35 offen offset:1024 lds
    buffer_load_dwordx4 v5, s[12:15], s35 offen offset:2048 lds
    buffer_load_dwordx4 v5, s[12:15], s35 offen offset:3072 lds
    s_add_u32 m0, s45, 73728
    s_lshl_b32 s35, s46, 17
    buffer_load_dwordx4 v10, s[16:19], s35 offen offset:0 lds
    buffer_load_dwordx4 v11, s[16:19], s35 offen offset:1024 lds
    s_add_u32 s46, s46, 1
    s_and_b32 s46, s46, 15
    s_waitcnt vmcnt(12)
    s_barrier
    s_add_u32 m0, s44, 98304
    s_lshl_b32 s35, s46, 13
    buffer_load_dwordx4 v5, s[12:15], s35 offen offset:0 lds
    buffer_load_dwordx4 v5, s[12:15], s35 offen offset:1024 lds
    buffer_load_dwordx4 v5, s[12:15], s35 offen offset:2048 lds
    buffer_load_dwordx4 v5, s[12:15], s35 offen offset:3072 lds
    s_add_u32 m0, s45, 98304
    s_lshl_b32 s35, s46, 17
    buffer_load_dwordx4 v10, s[16:19], s35 offen offset:0 lds
    buffer_load_dwordx4 v11, s[16:19], s35 offen offset:1024 lds
    s_add_u32 s46, s46, 1
    s_and_b32 s46, s46, 15
    s_waitcnt vmcnt(12)
    s_barrier
    s_add_u32 m0, s44, 122880
    s_lshl_b32 s35, s46, 13
    buffer_load_dwordx4 v5, s[12:15], s35 offen offset:0 lds
    buffer_load_dwordx4 v5, s[12:15], s35 offen offset:1024 lds
    buffer_load_dwordx4 v5, s[12:15], s35 offen offset:2048 lds
    buffer_load_dwordx4 v5, s[12:15], s35 offen offset:3072 lds
    s_add_u32 m0, s45, 122880
    s_lshl_b32 s35, s46, 17
    buffer_load_dwordx4 v10, s[16:19], s35 offen offset:0 lds
    buffer_load_dwordx4 v11, s[16:19], s35 offen offset:1024 lds
    s_add_u32 s46, s46, 1
    s_and_b32 s46, s46, 15
    s_waitcnt vmcnt(12)
    s_barrier
    s_add_u32 m0, s44, 0
    s_lshl_b32 s35, s46, 13
    buffer_load_dwordx4 v5, s[12:15], s35 offen offset:0 lds
    buffer_load_dwordx4 v5, s[12:15], s35 offen offset:1024 lds
    buffer_load_dwordx4 v5, s[12:15], s35 offen offset:2048 lds
    buffer_load_dwordx4 v5, s[12:15], s35 offen offset:3072 lds
    s_add_u32 m0, s45, 0
    s_lshl_b32 s35, s46, 17
    buffer_load_dwordx4 v10, s[16:19], s35 offen offset:0 lds
    buffer_load_dwordx4 v11, s[16:19], s35 offen offset:1024 lds
    s_add_u32 s46, s46, 1
    s_and_b32 s46, s46, 15
    s_waitcnt vmcnt(12)
    s_barrier
    s_add_u32 m0, s44, 24576
    s_lshl_b32 s35, s46, 13
    buffer_load_dwordx4 v5, s[12:15], s35 offen offset:0 lds
    buffer_load_dwordx4 v5, s[12:15], s35 offen offset:1024 lds
    buffer_load_dwordx4 v5, s[12:15], s35 offen offset:2048 lds
    buffer_load_dwordx4 v5, s[12:15], s35 offen offset:3072 lds
    s_add_u32 m0, s45, 24576
    s_lshl_b32 s35, s46, 17
    buffer_load_dwordx4 v10, s[16:19], s35 offen offset:0 lds
    buffer_load_dwordx4 v11, s[16:19], s35 offen offset:1024 lds
    s_add_u32 s46, s46, 1
    s_and_b32 s46, s46, 15
    s_waitcnt vmcnt(12)
    s_barrier
    s_add_u32 m0, s44, 49152
    s_lshl_b32 s35, s46, 13
    buffer_load_dwordx4 v5, s[12:15], s35 offen offset:0 lds
    buffer_load_dwordx4 v5, s[12:15], s35 offen offset:1024 lds
    buffer_load_dwordx4 v5, s[12:15], s35 offen offset:2048 lds
    buffer_load_dwordx4 v5, s[12:15], s35 offen offset:3072 lds
    s_add_u32 m0, s45, 49152
    s_lshl_b32 s35, s46, 17
    buffer_load_dwordx4 v10, s[16:19], s35 offen offset:0 lds
    buffer_load_dwordx4 v11, s[16:19], s35 offen offset:1024 lds
    s_add_u32 s46, s46, 1
    s_and_b32 s46, s46, 15
    s_waitcnt vmcnt(12)
    s_barrier
    s_add_u32 m0, s44, 73728
    s_lshl_b32 s35, s46, 13
    buffer_load_dwordx4 v5, s[12:15], s35 offen offset:0 lds
    buffer_load_dwordx4 v5, s[12:15], s35 offen offset:1024 lds
    buffer_load_dwordx4 v5, s[12:15], s35 offen offset:2048 lds
    buffer_load_dwordx4 v5, s[12:15], s35 offen offset:3072 lds
    s_add_u32 m0, s45, 73728
    s_lshl_b32 s35, s46, 17
    buffer_load_dwordx4 v10, s[16:19], s35 offen offset:0 lds
    buffer_load_dwordx4 v11, s[16:19], s35 offen offset:1024 lds
    s_add_u32 s46, s46, 1
    s_and_b32 s46, s46, 15
    s_waitcnt vmcnt(12)
    s_barrier
    s_add_u32 m0, s44, 98304
    s_lshl_b32 s35, s46, 13
    buffer_load_dwordx4 v5, s[12:15], s35 offen offset:0 lds
    buffer_load_dwordx4 v5, s[12:15], s35 offen offset:1024 lds
    buffer_load_dwordx4 v5, s[12:15], s35 offen offset:2048 lds
    buffer_load_dwordx4 v5, s[12:15], s35 offen offset:3072 lds
    s_add_u32 m0, s45, 98304
    s_lshl_b32 s35, s46, 17
    buffer_load_dwordx4 v10, s[16:19], s35 offen offset:0 lds
    buffer_load_dwordx4 v11, s[16:19], s35 offen offset:1024 lds
    s_add_u32 s46, s46, 1
    s_and_b32 s46, s46, 15
    s_waitcnt vmcnt(12)
    s_barrier
    s_add_u32 m0, s44, 122880
    s_lshl_b32 s35, s46, 13
    buffer_load_dwordx4 v5, s[12:15], s35 offen offset:0 lds
    buffer_load_dwordx4 v5, s[12:15], s35 offen offset:1024 lds
    buffer_load_dwordx4 v5, s[12:15], s35 offen offset:2048 lds
    buffer_load_dwordx4 v5, s[12:15], s35 offen offset:3072 lds
    s_add_u32 m0, s45, 122880
    s_lshl_b32 s35, s46, 17
    buffer_load_dwordx4 v10, s[16:19], s35 offen offset:0 lds
    buffer_load_dwordx4 v11, s[16:19], s35 offen offset:1024 lds
    s_add_u32 s46, s46, 1
    s_and_b32 s46, s46, 15
    s_waitcnt vmcnt(12)
    s_barrier
    s_waitcnt vmcnt(6)
    s_barrier
    s_waitcnt vmcnt(0)
    s_barrier
    s_branch k2_kernel_end
k2_kernel_compute:
    s_bfe_u32 s42, s32, 65537
    s_and_b32 s43, s32, 1
    v_and_b32 v1, 15, v0
    v_lshrrev_b32 v2, 4, v0
    v_lshrrev_b32 v3, 2, v1
    v_and_b32 v4, 3, v1
    s_lshl_b32 s35, s33, 1
    s_add_u32 s35, s35, s42
    v_lshlrev_b32 v5, 5, v1
    v_add_u32 v5, s35, v5
    v_lshlrev_b32 v6, 2, v5
    s_waitcnt lgkmcnt(0)
    s_add_u32 s24, s8, 12582912
    s_addc_u32 s25, s9, 0
    s_and_b32 s25, s25, 0xffff
    s_mov_b32 s26, 8192
    s_mov_b32 s27, 0x00020000
    s_mov_b32 s28, s6
    s_and_b32 s29, s7, 0xffff
    s_mov_b32 s30, 4194304
    s_mov_b32 s31, 0x00020000
    s_mov_b32 s36, 4096
    buffer_load_dword v23, v6, s[24:27], 0 offen offset:0
    buffer_load_dword v24, v6, s[24:27], 0 offen offset:2048
    buffer_load_dword v25, v6, s[24:27], s36 offen offset:0
    buffer_load_dword v26, v6, s[24:27], s36 offen offset:2048
    v_cvt_f32_u32 v19, v5
    v_mul_f32 v19, 973078528, v19
    v_add_f32 v20, 1048576000, v19
    v_add_f32 v21, 0.5, v19
    v_add_f32 v22, 1061158912, v19
    v_lshlrev_b32 v18, 3, v2
    v_cvt_f32_u32 v18, v18
    v_lshlrev_b32 v17, 11, v5
    v_and_b32 v6, 1, v2
    v_lshl_add_u32 v17, v6, 5, v17
    v_lshrrev_b32 v6, 1, v2
    v_lshl_add_u32 v17, v6, 4, v17
    s_lshl_b32 s35, s34, 7
    s_lshl_b32 s36, s43, 6
    s_add_u32 s35, s35, s36
    v_add_u32 v17, s35, v17
    v_and_b32 v5, 7, v1
    v_xor_b32 v5, v5, v2
    v_lshlrev_b32 v5, 4, v5
    v_lshl_add_u32 v7, v1, 7, v5
    s_lshl_b32 s37, s42, 13
    v_add_u32 v7, s37, v7
    v_xor_b32 v8, 64, v7
    v_lshl_add_u32 v9, v2, 3, v3
    v_lshlrev_b32 v9, 7, v9
    v_and_b32 v5, 1, v2
    v_lshlrev_b32 v5, 2, v5
    v_and_b32 v6, 2, v3
    v_or_b32 v5, v5, v6
    v_lshrrev_b32 v6, 1, v4
    s_lshl_b32 s35, s43, 2
    v_add_u32 v6, s35, v6
    v_xor_b32 v5, v5, v6
    v_lshl_add_u32 v9, v5, 4, v9
    v_and_b32 v5, 1, v4
    v_lshl_add_u32 v9, v5, 3, v9
    v_xor_b32 v10, 32, v9
    v_add_u32 v15, s37, v9
    v_add_u32 v16, s37, v10
    v_add_u32 v9, 16384, v9
    v_add_u32 v10, 16384, v10
    v_mul_f32 v32, v19, v18
    v_fract_f32 v32, v32
    v_add_f32 v33, v32, v19
    v_add_f32 v34, v33, v19
    v_add_f32 v35, v34, v19
    v_add_f32 v36, v35, v19
    v_add_f32 v37, v36, v19
    v_add_f32 v38, v37, v19
    v_add_f32 v39, v38, v19
    v_cos_f32 v40, v32
    v_cos_f32 v41, v33
    v_cos_f32 v42, v34
    v_cos_f32 v43, v35
    v_cos_f32 v44, v36
    v_cos_f32 v45, v37
    v_cos_f32 v46, v38
    v_cos_f32 v47, v39
    v_sin_f32_e64 v48, -v32
    v_sin_f32_e64 v49, -v33
    v_sin_f32_e64 v50, -v34
    v_sin_f32_e64 v51, -v35
    v_sin_f32_e64 v52, -v36
    v_sin_f32_e64 v53, -v37
    v_sin_f32_e64 v54, -v38
    v_sin_f32_e64 v55, -v39
    v_cvt_pk_bf16_f32 v120, v40, v41
    v_xor_b32 v128, 0x80000000, v120
    v_cvt_pk_bf16_f32 v121, v42, v43
    v_xor_b32 v129, 0x80000000, v121
    v_cvt_pk_bf16_f32 v122, v44, v45
    v_xor_b32 v130, 0x80000000, v122
    v_cvt_pk_bf16_f32 v123, v46, v47
    v_xor_b32 v131, 0x80000000, v123
    v_cvt_pk_bf16_f32 v168, v48, v49
    v_xor_b32 v176, 0x80000000, v168
    v_cvt_pk_bf16_f32 v169, v50, v51
    v_xor_b32 v177, 0x80000000, v169
    v_cvt_pk_bf16_f32 v170, v52, v53
    v_xor_b32 v178, 0x80000000, v170
    v_cvt_pk_bf16_f32 v171, v54, v55
    v_xor_b32 v179, 0x80000000, v171
    v_mul_f32 v32, v20, v18
    v_fract_f32 v32, v32
    v_add_f32 v33, v32, v20
    v_add_f32 v34, v33, v20
    v_add_f32 v35, v34, v20
    v_add_f32 v36, v35, v20
    v_add_f32 v37, v36, v20
    v_add_f32 v38, v37, v20
    v_add_f32 v39, v38, v20
    v_cos_f32 v40, v32
    v_cos_f32 v41, v33
    v_cos_f32 v42, v34
    v_cos_f32 v43, v35
    v_cos_f32 v44, v36
    v_cos_f32 v45, v37
    v_cos_f32 v46, v38
    v_cos_f32 v47, v39
    v_sin_f32_e64 v48, -v32
    v_sin_f32_e64 v49, -v33
    v_sin_f32_e64 v50, -v34
    v_sin_f32_e64 v51, -v35
    v_sin_f32_e64 v52, -v36
    v_sin_f32_e64 v53, -v37
    v_sin_f32_e64 v54, -v38
    v_sin_f32_e64 v55, -v39
    v_cvt_pk_bf16_f32 v124, v40, v41
    v_xor_b32 v132, 0x80000000, v124
    v_cvt_pk_bf16_f32 v125, v42, v43
    v_xor_b32 v133, 0x80000000, v125
    v_cvt_pk_bf16_f32 v126, v44, v45
    v_xor_b32 v134, 0x80000000, v126
    v_cvt_pk_bf16_f32 v127, v46, v47
    v_xor_b32 v135, 0x80000000, v127
    v_cvt_pk_bf16_f32 v172, v48, v49
    v_xor_b32 v180, 0x80000000, v172
    v_cvt_pk_bf16_f32 v173, v50, v51
    v_xor_b32 v181, 0x80000000, v173
    v_cvt_pk_bf16_f32 v174, v52, v53
    v_xor_b32 v182, 0x80000000, v174
    v_cvt_pk_bf16_f32 v175, v54, v55
    v_xor_b32 v183, 0x80000000, v175
    v_add_f32 v18, 1107296256, v18
    v_mul_f32 v32, v19, v18
    v_fract_f32 v32, v32
    v_add_f32 v33, v32, v19
    v_add_f32 v34, v33, v19
    v_add_f32 v35, v34, v19
    v_add_f32 v36, v35, v19
    v_add_f32 v37, v36, v19
    v_add_f32 v38, v37, v19
    v_add_f32 v39, v38, v19
    v_cos_f32 v40, v32
    v_cos_f32 v41, v33
    v_cos_f32 v42, v34
    v_cos_f32 v43, v35
    v_cos_f32 v44, v36
    v_cos_f32 v45, v37
    v_cos_f32 v46, v38
    v_cos_f32 v47, v39
    v_sin_f32_e64 v48, -v32
    v_sin_f32_e64 v49, -v33
    v_sin_f32_e64 v50, -v34
    v_sin_f32_e64 v51, -v35
    v_sin_f32_e64 v52, -v36
    v_sin_f32_e64 v53, -v37
    v_sin_f32_e64 v54, -v38
    v_sin_f32_e64 v55, -v39
    v_cvt_pk_bf16_f32 v136, v40, v41
    v_xor_b32 v144, 0x80000000, v136
    v_cvt_pk_bf16_f32 v137, v42, v43
    v_xor_b32 v145, 0x80000000, v137
    v_cvt_pk_bf16_f32 v138, v44, v45
    v_xor_b32 v146, 0x80000000, v138
    v_cvt_pk_bf16_f32 v139, v46, v47
    v_xor_b32 v147, 0x80000000, v139
    v_cvt_pk_bf16_f32 v184, v48, v49
    v_xor_b32 v192, 0x80000000, v184
    v_cvt_pk_bf16_f32 v185, v50, v51
    v_xor_b32 v193, 0x80000000, v185
    v_cvt_pk_bf16_f32 v186, v52, v53
    v_xor_b32 v194, 0x80000000, v186
    v_cvt_pk_bf16_f32 v187, v54, v55
    v_xor_b32 v195, 0x80000000, v187
    v_mul_f32 v32, v20, v18
    v_fract_f32 v32, v32
    v_add_f32 v33, v32, v20
    v_add_f32 v34, v33, v20
    v_add_f32 v35, v34, v20
    v_add_f32 v36, v35, v20
    v_add_f32 v37, v36, v20
    v_add_f32 v38, v37, v20
    v_add_f32 v39, v38, v20
    v_cos_f32 v40, v32
    v_cos_f32 v41, v33
    v_cos_f32 v42, v34
    v_cos_f32 v43, v35
    v_cos_f32 v44, v36
    v_cos_f32 v45, v37
    v_cos_f32 v46, v38
    v_cos_f32 v47, v39
    v_sin_f32_e64 v48, -v32
    v_sin_f32_e64 v49, -v33
    v_sin_f32_e64 v50, -v34
    v_sin_f32_e64 v51, -v35
    v_sin_f32_e64 v52, -v36
    v_sin_f32_e64 v53, -v37
    v_sin_f32_e64 v54, -v38
    v_sin_f32_e64 v55, -v39
    v_cvt_pk_bf16_f32 v140, v40, v41
    v_xor_b32 v148, 0x80000000, v140
    v_cvt_pk_bf16_f32 v141, v42, v43
    v_xor_b32 v149, 0x80000000, v141
    v_cvt_pk_bf16_f32 v142, v44, v45
    v_xor_b32 v150, 0x80000000, v142
    v_cvt_pk_bf16_f32 v143, v46, v47
    v_xor_b32 v151, 0x80000000, v143
    v_cvt_pk_bf16_f32 v188, v48, v49
    v_xor_b32 v196, 0x80000000, v188
    v_cvt_pk_bf16_f32 v189, v50, v51
    v_xor_b32 v197, 0x80000000, v189
    v_cvt_pk_bf16_f32 v190, v52, v53
    v_xor_b32 v198, 0x80000000, v190
    v_cvt_pk_bf16_f32 v191, v54, v55
    v_xor_b32 v199, 0x80000000, v191
    s_mov_b32 s39, 49152
    v_add_u32 v11, s39, v7
    v_add_u32 v13, s39, v9
    v_add_u32 v14, s39, v10
    v_add_u32 v12, s39, v8
    s_barrier
    ds_read_b64_tr_b16 v[152:153], v15 offset:0
    ds_read_b64_tr_b16 v[154:155], v15 offset:512
    ds_read_b64_tr_b16 v[156:157], v16 offset:0
    ds_read_b64_tr_b16 v[158:159], v16 offset:512
    ds_read_b64_tr_b16 v[160:161], v15 offset:4096
    ds_read_b64_tr_b16 v[162:163], v15 offset:4608
    ds_read_b64_tr_b16 v[164:165], v16 offset:4096
    ds_read_b64_tr_b16 v[166:167], v16 offset:4608
    s_waitcnt lgkmcnt(0)
    s_barrier
    v_mfma_f32_16x16x32_bf16 v[88:91], v[152:155], v[120:123], 0
    ds_read_b64_tr_b16 v[200:201], v15 offset:24576
    ds_read_b64_tr_b16 v[202:203], v15 offset:25088
    v_mfma_f32_16x16x32_bf16 v[92:95], v[156:159], v[120:123], 0
    ds_read_b64_tr_b16 v[204:205], v16 offset:24576
    ds_read_b64_tr_b16 v[206:207], v16 offset:25088
    v_mfma_f32_16x16x32_bf16 v[96:99], v[152:155], v[124:127], 0
    ds_read_b64_tr_b16 v[208:209], v15 offset:28672
    ds_read_b64_tr_b16 v[210:211], v15 offset:29184
    v_mfma_f32_16x16x32_bf16 v[100:103], v[156:159], v[124:127], 0
    ds_read_b64_tr_b16 v[212:213], v16 offset:28672
    ds_read_b64_tr_b16 v[214:215], v16 offset:29184
    v_mfma_f32_16x16x32_bf16 v[104:107], v[152:155], v[128:131], 0
    v_mfma_f32_16x16x32_bf16 v[108:111], v[156:159], v[128:131], 0
    v_mfma_f32_16x16x32_bf16 v[112:115], v[152:155], v[132:135], 0
    v_mfma_f32_16x16x32_bf16 v[116:119], v[156:159], v[132:135], 0
    v_mfma_f32_16x16x32_bf16 v[88:91], v[160:163], v[136:139], v[88:91]
    v_mfma_f32_16x16x32_bf16 v[92:95], v[164:167], v[136:139], v[92:95]
    v_mfma_f32_16x16x32_bf16 v[96:99], v[160:163], v[140:143], v[96:99]
    v_mfma_f32_16x16x32_bf16 v[100:103], v[164:167], v[140:143], v[100:103]
    v_mfma_f32_16x16x32_bf16 v[104:107], v[160:163], v[144:147], v[104:107]
    v_mfma_f32_16x16x32_bf16 v[108:111], v[164:167], v[144:147], v[108:111]
    v_mfma_f32_16x16x32_bf16 v[112:115], v[160:163], v[148:151], v[112:115]
    v_mfma_f32_16x16x32_bf16 v[116:119], v[164:167], v[148:151], v[116:119]
    s_waitcnt lgkmcnt(0)
    s_barrier
    v_mfma_f32_16x16x32_bf16 v[88:91], v[200:203], v[168:171], v[88:91]
    ds_read_b64_tr_b16 v[152:153], v13 offset:0
    ds_read_b64_tr_b16 v[154:155], v13 offset:512
    v_mfma_f32_16x16x32_bf16 v[92:95], v[204:207], v[168:171], v[92:95]
    ds_read_b128 v[120:123], v11 offset:0
    ds_read_b64_tr_b16 v[156:157], v14 offset:0
    v_mfma_f32_16x16x32_bf16 v[96:99], v[200:203], v[172:175], v[96:99]
    ds_read_b64_tr_b16 v[158:159], v14 offset:512
    ds_read_b128 v[124:127], v11 offset:2048
    v_mfma_f32_16x16x32_bf16 v[100:103], v[204:207], v[172:175], v[100:103]
    ds_read_b128 v[128:131], v11 offset:4096
    ds_read_b128 v[132:135], v11 offset:6144
    v_mfma_f32_16x16x32_bf16 v[104:107], v[200:203], v[176:179], v[104:107]
    ds_read_b64_tr_b16 v[160:161], v13 offset:4096
    ds_read_b64_tr_b16 v[162:163], v13 offset:4608
    v_mfma_f32_16x16x32_bf16 v[108:111], v[204:207], v[176:179], v[108:111]
    ds_read_b128 v[136:139], v12 offset:0
    ds_read_b64_tr_b16 v[164:165], v14 offset:4096
    v_mfma_f32_16x16x32_bf16 v[112:115], v[200:203], v[180:183], v[112:115]
    ds_read_b64_tr_b16 v[166:167], v14 offset:4608
    ds_read_b128 v[140:143], v12 offset:2048
    v_mfma_f32_16x16x32_bf16 v[116:119], v[204:207], v[180:183], v[116:119]
    ds_read_b128 v[144:147], v12 offset:4096
    ds_read_b128 v[148:151], v12 offset:6144
    v_mfma_f32_16x16x32_bf16 v[88:91], v[208:211], v[184:187], v[88:91]
    s_add_u32 s39, s39, 24576
    s_cmp_eq_u32 s39, 147456
    v_mfma_f32_16x16x32_bf16 v[92:95], v[212:215], v[184:187], v[92:95]
    s_cselect_b32 s39, 0, s39
    v_add_u32 v11, s39, v7
    v_mfma_f32_16x16x32_bf16 v[96:99], v[208:211], v[188:191], v[96:99]
    v_add_u32 v13, s39, v9
    v_add_u32 v14, s39, v10
    v_mfma_f32_16x16x32_bf16 v[100:103], v[212:215], v[188:191], v[100:103]
    v_add_u32 v12, s39, v8
    v_mfma_f32_16x16x32_bf16 v[104:107], v[208:211], v[192:195], v[104:107]
    v_mfma_f32_16x16x32_bf16 v[108:111], v[212:215], v[192:195], v[108:111]
    v_mfma_f32_16x16x32_bf16 v[112:115], v[208:211], v[196:199], v[112:115]
    v_mfma_f32_16x16x32_bf16 v[116:119], v[212:215], v[196:199], v[116:119]
    s_waitcnt vmcnt(0)
    v_sub_f32 v27, 1.0, v23
    v_cvt_pk_bf16_f32 v27, 0, v27
    v_sub_f32 v28, 1.0, v24
    v_cvt_pk_bf16_f32 v28, 0, v28
    v_sub_f32 v29, 1.0, v25
    v_cvt_pk_bf16_f32 v29, 0, v29
    v_sub_f32 v30, 1.0, v26
    v_cvt_pk_bf16_f32 v30, 0, v30
    s_waitcnt lgkmcnt(0)
    s_barrier
    v_mfma_f32_16x16x32_bf16 v[56:59], v[152:155], v[120:123], 0
    ds_read_b64_tr_b16 v[200:201], v13 offset:0
    ds_read_b64_tr_b16 v[202:203], v13 offset:512
    v_mfma_f32_16x16x32_bf16 v[60:63], v[156:159], v[120:123], 0
    ds_read_b128 v[168:171], v11 offset:0
    ds_read_b64_tr_b16 v[204:205], v14 offset:0
    v_mfma_f32_16x16x32_bf16 v[64:67], v[152:155], v[124:127], 0
    ds_read_b64_tr_b16 v[206:207], v14 offset:512
    ds_read_b128 v[172:175], v11 offset:2048
    v_mfma_f32_16x16x32_bf16 v[68:71], v[156:159], v[124:127], 0
    ds_read_b128 v[176:179], v11 offset:4096
    ds_read_b128 v[180:183], v11 offset:6144
    v_mfma_f32_16x16x32_bf16 v[72:75], v[152:155], v[128:131], 0
    ds_read_b64_tr_b16 v[208:209], v13 offset:4096
    ds_read_b64_tr_b16 v[210:211], v13 offset:4608
    v_mfma_f32_16x16x32_bf16 v[76:79], v[156:159], v[128:131], 0
    ds_read_b128 v[184:187], v12 offset:0
    ds_read_b64_tr_b16 v[212:213], v14 offset:4096
    v_mfma_f32_16x16x32_bf16 v[80:83], v[152:155], v[132:135], 0
    ds_read_b64_tr_b16 v[214:215], v14 offset:4608
    ds_read_b128 v[188:191], v12 offset:2048
    v_mfma_f32_16x16x32_bf16 v[84:87], v[156:159], v[132:135], 0
    ds_read_b128 v[192:195], v12 offset:4096
    ds_read_b128 v[196:199], v12 offset:6144
    v_mfma_f32_16x16x32_bf16 v[56:59], v[160:163], v[136:139], v[56:59]
    s_add_u32 s39, s39, 24576
    s_cmp_eq_u32 s39, 147456
    v_mfma_f32_16x16x32_bf16 v[60:63], v[164:167], v[136:139], v[60:63]
    s_cselect_b32 s39, 0, s39
    v_add_u32 v11, s39, v7
    v_mfma_f32_16x16x32_bf16 v[64:67], v[160:163], v[140:143], v[64:67]
    v_add_u32 v13, s39, v9
    v_add_u32 v14, s39, v10
    v_mfma_f32_16x16x32_bf16 v[68:71], v[164:167], v[140:143], v[68:71]
    v_add_u32 v12, s39, v8
    v_mul_f32 v88, v88, v27
    v_mfma_f32_16x16x32_bf16 v[72:75], v[160:163], v[144:147], v[72:75]
    v_mul_f32 v89, v89, v27
    v_mul_f32 v90, v90, v27
    v_mfma_f32_16x16x32_bf16 v[76:79], v[164:167], v[144:147], v[76:79]
    v_mul_f32 v91, v91, v27
    v_mul_f32 v92, v92, v27
    v_mfma_f32_16x16x32_bf16 v[80:83], v[160:163], v[148:151], v[80:83]
    v_mul_f32 v93, v93, v27
    v_mul_f32 v94, v94, v27
    v_mfma_f32_16x16x32_bf16 v[84:87], v[164:167], v[148:151], v[84:87]
    v_mul_f32 v95, v95, v27
    v_mul_f32 v96, v96, v28
    v_mul_f32 v97, v97, v28
    v_mul_f32 v98, v98, v28
    v_mul_f32 v99, v99, v28
    v_mul_f32 v100, v100, v28
    v_mul_f32 v101, v101, v28
    v_mul_f32 v102, v102, v28
    v_mul_f32 v103, v103, v28
    v_mul_f32 v104, v104, v29
    v_mul_f32 v105, v105, v29
    v_mul_f32 v106, v106, v29
    v_mul_f32 v107, v107, v29
    v_mul_f32 v108, v108, v29
    v_mul_f32 v109, v109, v29
    v_mul_f32 v110, v110, v29
    v_mul_f32 v111, v111, v29
    v_mul_f32 v112, v112, v30
    v_mul_f32 v113, v113, v30
    v_mul_f32 v114, v114, v30
    v_mul_f32 v115, v115, v30
    v_mul_f32 v116, v116, v30
    v_mul_f32 v117, v117, v30
    v_mul_f32 v118, v118, v30
    v_mul_f32 v119, v119, v30
    s_mov_b32 s40, 0
k2_kernel_cloop:
    s_waitcnt lgkmcnt(0)
    s_barrier
    v_mfma_f32_16x16x32_bf16 v[56:59], v[200:203], v[168:171], v[56:59]
    ds_read_b64_tr_b16 v[152:153], v13 offset:0
    ds_read_b64_tr_b16 v[154:155], v13 offset:512
    v_mfma_f32_16x16x32_bf16 v[60:63], v[204:207], v[168:171], v[60:63]
    ds_read_b128 v[120:123], v11 offset:0
    ds_read_b64_tr_b16 v[156:157], v14 offset:0
    v_mfma_f32_16x16x32_bf16 v[64:67], v[200:203], v[172:175], v[64:67]
    ds_read_b64_tr_b16 v[158:159], v14 offset:512
    ds_read_b128 v[124:127], v11 offset:2048
    v_mfma_f32_16x16x32_bf16 v[68:71], v[204:207], v[172:175], v[68:71]
    ds_read_b128 v[128:131], v11 offset:4096
    ds_read_b128 v[132:135], v11 offset:6144
    v_mfma_f32_16x16x32_bf16 v[72:75], v[200:203], v[176:179], v[72:75]
    ds_read_b64_tr_b16 v[160:161], v13 offset:4096
    ds_read_b64_tr_b16 v[162:163], v13 offset:4608
    v_mfma_f32_16x16x32_bf16 v[76:79], v[204:207], v[176:179], v[76:79]
    ds_read_b128 v[136:139], v12 offset:0
    ds_read_b64_tr_b16 v[164:165], v14 offset:4096
    v_mfma_f32_16x16x32_bf16 v[80:83], v[200:203], v[180:183], v[80:83]
    ds_read_b64_tr_b16 v[166:167], v14 offset:4608
    ds_read_b128 v[140:143], v12 offset:2048
    v_mfma_f32_16x16x32_bf16 v[84:87], v[204:207], v[180:183], v[84:87]
    ds_read_b128 v[144:147], v12 offset:4096
    ds_read_b128 v[148:151], v12 offset:6144
    v_mfma_f32_16x16x32_bf16 v[56:59], v[208:211], v[184:187], v[56:59]
    s_add_u32 s39, s39, 24576
    s_cmp_eq_u32 s39, 147456
    v_mfma_f32_16x16x32_bf16 v[60:63], v[212:215], v[184:187], v[60:63]
    s_cselect_b32 s39, 0, s39
    v_add_u32 v11, s39, v7
    v_mfma_f32_16x16x32_bf16 v[64:67], v[208:211], v[188:191], v[64:67]
    v_add_u32 v13, s39, v9
    v_add_u32 v14, s39, v10
    v_mfma_f32_16x16x32_bf16 v[68:71], v[212:215], v[188:191], v[68:71]
    v_add_u32 v12, s39, v8
    v_mfma_f32_16x16x32_bf16 v[72:75], v[208:211], v[192:195], v[72:75]
    v_mfma_f32_16x16x32_bf16 v[76:79], v[212:215], v[192:195], v[76:79]
    v_mfma_f32_16x16x32_bf16 v[80:83], v[208:211], v[196:199], v[80:83]
    v_mfma_f32_16x16x32_bf16 v[84:87], v[212:215], v[196:199], v[84:87]
    s_waitcnt lgkmcnt(0)
    s_barrier
    v_mfma_f32_16x16x32_bf16 v[56:59], v[152:155], v[120:123], v[56:59]
    ds_read_b64_tr_b16 v[200:201], v13 offset:0
    ds_read_b64_tr_b16 v[202:203], v13 offset:512
    v_mfma_f32_16x16x32_bf16 v[60:63], v[156:159], v[120:123], v[60:63]
    ds_read_b128 v[168:171], v11 offset:0
    ds_read_b64_tr_b16 v[204:205], v14 offset:0
    v_mfma_f32_16x16x32_bf16 v[64:67], v[152:155], v[124:127], v[64:67]
    ds_read_b64_tr_b16 v[206:207], v14 offset:512
    ds_read_b128 v[172:175], v11 offset:2048
    v_mfma_f32_16x16x32_bf16 v[68:71], v[156:159], v[124:127], v[68:71]
    ds_read_b128 v[176:179], v11 offset:4096
    ds_read_b128 v[180:183], v11 offset:6144
    v_mfma_f32_16x16x32_bf16 v[72:75], v[152:155], v[128:131], v[72:75]
    ds_read_b64_tr_b16 v[208:209], v13 offset:4096
    ds_read_b64_tr_b16 v[210:211], v13 offset:4608
    v_mfma_f32_16x16x32_bf16 v[76:79], v[156:159], v[128:131], v[76:79]
    ds_read_b128 v[184:187], v12 offset:0
    ds_read_b64_tr_b16 v[212:213], v14 offset:4096
    v_mfma_f32_16x16x32_bf16 v[80:83], v[152:155], v[132:135], v[80:83]
    ds_read_b64_tr_b16 v[214:215], v14 offset:4608
    ds_read_b128 v[188:191], v12 offset:2048
    v_mfma_f32_16x16x32_bf16 v[84:87], v[156:159], v[132:135], v[84:87]
    ds_read_b128 v[192:195], v12 offset:4096
    ds_read_b128 v[196:199], v12 offset:6144
    v_mfma_f32_16x16x32_bf16 v[56:59], v[160:163], v[136:139], v[56:59]
    s_add_u32 s39, s39, 24576
    s_cmp_eq_u32 s39, 147456
    v_mfma_f32_16x16x32_bf16 v[60:63], v[164:167], v[136:139], v[60:63]
    s_cselect_b32 s39, 0, s39
    v_add_u32 v11, s39, v7
    v_mfma_f32_16x16x32_bf16 v[64:67], v[160:163], v[140:143], v[64:67]
    v_add_u32 v13, s39, v9
    v_add_u32 v14, s39, v10
    v_mfma_f32_16x16x32_bf16 v[68:71], v[164:167], v[140:143], v[68:71]
    v_add_u32 v12, s39, v8
    s_add_u32 s40, s40, 1
    v_mfma_f32_16x16x32_bf16 v[72:75], v[160:163], v[144:147], v[72:75]
    s_cmp_lt_u32 s40, 7
    v_mfma_f32_16x16x32_bf16 v[76:79], v[164:167], v[144:147], v[76:79]
    v_mfma_f32_16x16x32_bf16 v[80:83], v[160:163], v[148:151], v[80:83]
    v_mfma_f32_16x16x32_bf16 v[84:87], v[164:167], v[148:151], v[84:87]
    s_cbranch_scc1 k2_kernel_cloop
    s_waitcnt lgkmcnt(0)
    v_mfma_f32_16x16x32_bf16 v[56:59], v[200:203], v[168:171], v[56:59]
    v_mfma_f32_16x16x32_bf16 v[60:63], v[204:207], v[168:171], v[60:63]
    v_mfma_f32_16x16x32_bf16 v[56:59], v[208:211], v[184:187], v[56:59]
    v_mfma_f32_16x16x32_bf16 v[60:63], v[212:215], v[184:187], v[60:63]
    v_mfma_f32_16x16x32_bf16 v[64:67], v[200:203], v[172:175], v[64:67]
    v_mfma_f32_16x16x32_bf16 v[68:71], v[204:207], v[172:175], v[68:71]
    v_mfma_f32_16x16x32_bf16 v[64:67], v[208:211], v[188:191], v[64:67]
    v_mfma_f32_16x16x32_bf16 v[68:71], v[212:215], v[188:191], v[68:71]
    v_mfma_f32_16x16x32_bf16 v[72:75], v[200:203], v[176:179], v[72:75]
    v_mfma_f32_16x16x32_bf16 v[76:79], v[204:207], v[176:179], v[76:79]
    v_mfma_f32_16x16x32_bf16 v[72:75], v[208:211], v[192:195], v[72:75]
    v_mfma_f32_16x16x32_bf16 v[76:79], v[212:215], v[192:195], v[76:79]
    v_cvt_pk_bf16_f32 v56, 0, v56
    v_cvt_pk_bf16_f32 v57, 0, v57
    v_cvt_pk_bf16_f32 v58, 0, v58
    v_mfma_f32_16x16x32_bf16 v[80:83], v[200:203], v[180:183], v[80:83]
    v_cvt_pk_bf16_f32 v59, 0, v59
    v_fma_f32 v56, v56, v23, v88
    v_fma_f32 v57, v57, v23, v89
    v_mfma_f32_16x16x32_bf16 v[84:87], v[204:207], v[180:183], v[84:87]
    v_fma_f32 v58, v58, v23, v90
    v_fma_f32 v59, v59, v23, v91
    v_cvt_pk_bf16_f32 v32, v56, v57
    v_mfma_f32_16x16x32_bf16 v[80:83], v[208:211], v[196:199], v[80:83]
    v_cvt_pk_bf16_f32 v33, v58, v59
    v_cvt_pk_bf16_f32 v60, 0, v60
    v_cvt_pk_bf16_f32 v61, 0, v61
    v_mfma_f32_16x16x32_bf16 v[84:87], v[212:215], v[196:199], v[84:87]
    v_cvt_pk_bf16_f32 v62, 0, v62
    v_cvt_pk_bf16_f32 v63, 0, v63
    v_fma_f32 v60, v60, v23, v92
    v_fma_f32 v61, v61, v23, v93
    v_fma_f32 v62, v62, v23, v94
    v_fma_f32 v63, v63, v23, v95
    v_cvt_pk_bf16_f32 v34, v60, v61
    v_cvt_pk_bf16_f32 v35, v62, v63
    s_mov_b32 s35, 0
    s_nop 0
    v_permlane16_swap_b32 v32, v34
    v_permlane16_swap_b32 v33, v35
    buffer_store_dwordx4 v[32:35], v17, s[28:31], s35 offen sc1
    v_cvt_pk_bf16_f32 v64, 0, v64
    v_cvt_pk_bf16_f32 v65, 0, v65
    v_cvt_pk_bf16_f32 v66, 0, v66
    v_cvt_pk_bf16_f32 v67, 0, v67
    v_fma_f32 v64, v64, v24, v96
    v_fma_f32 v65, v65, v24, v97
    v_fma_f32 v66, v66, v24, v98
    v_fma_f32 v67, v67, v24, v99
    v_cvt_pk_bf16_f32 v36, v64, v65
    v_cvt_pk_bf16_f32 v37, v66, v67
    v_cvt_pk_bf16_f32 v68, 0, v68
    v_cvt_pk_bf16_f32 v69, 0, v69
    v_cvt_pk_bf16_f32 v70, 0, v70
    v_cvt_pk_bf16_f32 v71, 0, v71
    v_fma_f32 v68, v68, v24, v100
    v_fma_f32 v69, v69, v24, v101
    v_fma_f32 v70, v70, v24, v102
    v_fma_f32 v71, v71, v24, v103
    v_cvt_pk_bf16_f32 v38, v68, v69
    v_cvt_pk_bf16_f32 v39, v70, v71
    s_mov_b32 s35, 1048576
    s_nop 0
    v_permlane16_swap_b32 v36, v38
    v_permlane16_swap_b32 v37, v39
    buffer_store_dwordx4 v[36:39], v17, s[28:31], s35 offen sc1
    v_cvt_pk_bf16_f32 v72, 0, v72
    v_cvt_pk_bf16_f32 v73, 0, v73
    v_cvt_pk_bf16_f32 v74, 0, v74
    v_cvt_pk_bf16_f32 v75, 0, v75
    v_fma_f32 v72, v72, v25, v104
    v_fma_f32 v73, v73, v25, v105
    v_fma_f32 v74, v74, v25, v106
    v_fma_f32 v75, v75, v25, v107
    v_cvt_pk_bf16_f32 v40, v72, v73
    v_cvt_pk_bf16_f32 v41, v74, v75
    v_cvt_pk_bf16_f32 v76, 0, v76
    v_cvt_pk_bf16_f32 v77, 0, v77
    v_cvt_pk_bf16_f32 v78, 0, v78
    v_cvt_pk_bf16_f32 v79, 0, v79
    v_fma_f32 v76, v76, v25, v108
    v_fma_f32 v77, v77, v25, v109
    v_fma_f32 v78, v78, v25, v110
    v_fma_f32 v79, v79, v25, v111
    v_cvt_pk_bf16_f32 v42, v76, v77
    v_cvt_pk_bf16_f32 v43, v78, v79
    s_mov_b32 s35, 2097152
    s_nop 0
    v_permlane16_swap_b32 v40, v42
    v_permlane16_swap_b32 v41, v43
    buffer_store_dwordx4 v[40:43], v17, s[28:31], s35 offen sc1
    v_cvt_pk_bf16_f32 v80, 0, v80
    v_cvt_pk_bf16_f32 v81, 0, v81
    v_cvt_pk_bf16_f32 v82, 0, v82
    v_cvt_pk_bf16_f32 v83, 0, v83
    v_fma_f32 v80, v80, v26, v112
    v_fma_f32 v81, v81, v26, v113
    v_fma_f32 v82, v82, v26, v114
    v_fma_f32 v83, v83, v26, v115
    v_cvt_pk_bf16_f32 v44, v80, v81
    v_cvt_pk_bf16_f32 v45, v82, v83
    v_cvt_pk_bf16_f32 v84, 0, v84
    v_cvt_pk_bf16_f32 v85, 0, v85
    v_cvt_pk_bf16_f32 v86, 0, v86
    v_cvt_pk_bf16_f32 v87, 0, v87
    v_fma_f32 v84, v84, v26, v116
    v_fma_f32 v85, v85, v26, v117
    v_fma_f32 v86, v86, v26, v118
    v_fma_f32 v87, v87, v26, v119
    v_cvt_pk_bf16_f32 v46, v84, v85
    v_cvt_pk_bf16_f32 v47, v86, v87
    s_mov_b32 s35, 3145728
    s_nop 0
    v_permlane16_swap_b32 v44, v46
    v_permlane16_swap_b32 v45, v47
    buffer_store_dwordx4 v[44:47], v17, s[28:31], s35 offen sc1
k2_kernel_end:
    s_endpgm

code_end:
.section .rodata,"a"
.p2align 6
.amdhsa_kernel k1_kernel
  .amdhsa_next_free_vgpr 252
  .amdhsa_next_free_sgpr 102
  .amdhsa_accum_offset 252
  .amdhsa_group_segment_fixed_size 0
  .amdhsa_kernarg_size 96
  .amdhsa_user_sgpr_count 2
  .amdhsa_user_sgpr_kernarg_segment_ptr 1
  .amdhsa_system_sgpr_workgroup_id_x 1
.end_amdhsa_kernel
.p2align 6
.amdhsa_kernel k2_kernel
  .amdhsa_next_free_vgpr 216
  .amdhsa_next_free_sgpr 102
  .amdhsa_accum_offset 216
  .amdhsa_group_segment_fixed_size 0
  .amdhsa_kernarg_size 96
  .amdhsa_user_sgpr_count 2
  .amdhsa_user_sgpr_kernarg_segment_ptr 1
  .amdhsa_system_sgpr_workgroup_id_x 1
.end_amdhsa_kernel
```
